```python
import torch

def _softmax(x, axis=-1):
    return torch.softmax(x, dim=axis)
def _gelu(x):
    return torch.nn.functional.gelu(x, approximate="tanh")
def _silu(x):
    return torch.nn.functional.silu(x)
def _sigmoid(x):
    return torch.sigmoid(x)
def _layernorm(x, axis=-1, eps=1e-5):
    m = x.mean(dim=axis, keepdim=True)
    v = x.var(dim=axis, keepdim=True, unbiased=False)
    return (x - m) / torch.sqrt(v + eps)
def _scatter_add(tgt, idx, src, axis=0):
    return tgt.clone().index_add_(axis, idx, src)
def _segment_sum(src, seg, n):
    out = torch.zeros((n,) + src.shape[1:], dtype=src.dtype)
    return out.index_add_(0, seg, src)
def _pad(x, pw):
    flat = tuple(v for pair in reversed(pw) for v in pair)
    return torch.nn.functional.pad(x, flat)

kernel_name = 'gated_mix__grouped_kv_mqa__moe_arch_mod__prompt'

def setup_inputs():

    _w = (lambda a: (lambda t: t.to(torch.bfloat16) if t.is_floating_point() else t)(torch.as_tensor(a)))
    def _A_setup():
        B, S, D, H = 1, 2048, 640, 32
        Dh = D // H
        return {
            "x": _w((lambda *s: torch.randn(*s, dtype=torch.bfloat16) * 0.05)(B, S, D)),
            "wq": _w((lambda *s: torch.randn(*s, dtype=torch.bfloat16) * 3.2)(D, H * Dh)),
            "wk": _w((lambda *s: torch.randn(*s, dtype=torch.bfloat16) * 3.2)(D, Dh)),
            "wv": _w((lambda *s: torch.randn(*s, dtype=torch.bfloat16) * 0.4)(D, Dh)),
            "wo": _w((lambda *s: torch.randn(*s, dtype=torch.bfloat16) * 0.4)(H * Dh, D)),
        }
    _A_in = _A_setup()

    def _B_setup():
        B, S, D, F, C = 1, 2048, 640, 1728, 1
        return {
            "x": _w((lambda *s: torch.randn(*s, dtype=torch.bfloat16) * 0.05)(B, S, D)),
            "w_r": _w((lambda *s: torch.randn(*s, dtype=torch.bfloat16) * 1.6)(D)),
            "w_gate": _w((lambda *s: torch.randn(*s, dtype=torch.bfloat16) * 0.8)(D, F)),
            "w_up": _w((lambda *s: torch.randn(*s, dtype=torch.bfloat16) * 0.8)(D, F)),
            "w_down": _w((lambda *s: torch.randn(*s, dtype=torch.bfloat16) * 0.8)(F, D)),
        }
    _B_in = _B_setup()

    return {
        "A_x": _A_in["x"],
        "A_wq": _A_in["wq"],
        "A_wk": _A_in["wk"],
        "A_wv": _A_in["wv"],
        "A_wo": _A_in["wo"],
        "B_x": _B_in["x"],
        "B_w_r": _B_in["w_r"],
        "B_w_gate": _B_in["w_gate"],
        "B_w_up": _B_in["w_up"],
        "B_w_down": _B_in["w_down"],
        "gate_w": _w((lambda *s: torch.randn(*s, dtype=torch.bfloat16) * 0.05)(640) * 16.0),
    }

def reference(A_x, A_wq, A_wk, A_wv, A_wo, B_x, B_w_r, B_w_gate, B_w_up, B_w_down, gate_w):
    def _A_ref(x, wq, wk, wv, wo):
        B, S, D = x.shape
        H = 32
        Dh = D // H
        q = (lambda x, *d: x.permute(*d))((x @ wq).reshape(B, S, H, Dh), 0, 2, 1, 3)
        k = x @ wk
        v = x @ wv
        scores = torch.einsum("bhqd,bkd->bhqk", q, k) * (Dh ** -0.5)
        p = _softmax(scores, axis=-1)
        o = torch.einsum("bhqk,bkd->bhqd", p, v)
        return (lambda x, *d: x.permute(*d))(o, 0, 2, 1, 3).reshape(B, S, H * Dh) @ wo

    def _B_ref(x, w_r, w_gate, w_up, w_down):
        B, S, D = x.shape
        C = 1
        r = x @ w_r
        idx = torch.argsort(-r, axis=-1)[:, :C]
        idx_e = (lambda x, n, axis: torch.repeat_interleave(x, n, dim=axis))(idx.reshape(B, C, 1), D, axis=2)
        x_sel = (lambda x, i, axis: torch.take_along_dim(x, i, dim=axis))(x, idx_e, axis=1)
        g = _silu(x_sel @ w_gate)
        u = x_sel @ w_up
        y = (g * u) @ w_down
        r_sel = _sigmoid((lambda x, i, axis: torch.take_along_dim(x, i, dim=axis))(r, idx, axis=1))
        y = y * r_sel.reshape(B, C, 1)
        b_off = (torch.arange(B) * S).reshape(B, 1)
        flat_idx = (idx + b_off).reshape(B * C)
        zero = (x * 0.0).reshape(B * S, D)
        upd = _scatter_add(zero, flat_idx, y.reshape(B * C, D), axis=0)
        return x + upd.reshape(B, S, D)

    x = A_x
    g = _sigmoid((x * gate_w).sum(-1, keepdims=True))
    a = _A_ref(x, A_wq, A_wk, A_wv, A_wo)
    b = _B_ref(x, B_w_r, B_w_gate, B_w_up, B_w_down)
    return g * a + (1 - g) * b
```

```asm
; @launch grid=(256,1,1) block=(512,1,1) lds=163840
.amdgcn_target "amdgcn-amd-amdhsa--gfx950"
.text
.globl gated_mix__grouped_kv_mqa__moe_arch_mod__prompt_kernel
.p2align 8
.type gated_mix__grouped_kv_mqa__moe_arch_mod__prompt_kernel,@function
gated_mix__grouped_kv_mqa__moe_arch_mod__prompt_kernel:
    s_cmpk_lt_u32 s2, 256
    s_cbranch_scc0 L_end
    s_load_dwordx8 s[56:63], s[0:1], 0
    s_load_dwordx16 s[64:79], s[0:1], 32
    s_load_dwordx4 s[80:83], s[0:1], 96
    s_memrealtime s[92:93]
    s_getpc_b64 s[94:95]
L_pc:
    s_bfe_u32 s3, s2, 0x20003
    v_lshl_add_u32 v1, v0, 2, s3
    v_min_u32 v1, (L_end-L_pc)/128, v1
    v_lshlrev_b32 v1, 7, v1
    global_load_dword v251, v1, s[94:95]
    v_lshrrev_b32 v1, 6, v0
    v_and_b32 v0, 63, v0
    v_readfirstlane_b32 s3, v1
    v_and_b32 v7, 15, v0
    v_lshrrev_b32 v8, 4, v0
    s_and_b32 s4, s2, 31
    s_lshr_b32 s5, s2, 5
    s_lshr_b32 s7, s2, 6
    s_and_b32 s88, s3, 3
    v_xor_b32 v9, v7, v8
    v_lshlrev_b32 v9, 4, v9
    s_lshl_b32 s94, s88, 6
    s_lshl4_add_u32 s95, s4, s88
    s_mulk_i32 s95, 5120
    v_xor_b32 v1, s94, v9
    v_mul_u32_u24 v10, 1280, v8
    v_add3_u32 v1, v1, v10, s95
    v_lshlrev_b32 v5, 4, v0
    s_mov_b32 s10, 2621440
    s_mov_b32 s11, 0x20000
    s_movk_i32 s18, 25600
    s_mov_b32 s19, 0x20000
    s_mul_i32 s94, s7, 20480
    s_lshl_b32 s96, s88, 10
    s_add_u32 s95, s94, s96
    s_mulk_i32 s96, 6
    s_bitcmp1_b32 s5, 0
    s_waitcnt lgkmcnt(0)
    s_mov_b64 s[8:9], s[56:57]
    s_cselect_b64 s[16:17], s[62:63], s[60:61]
    s_cmp_ge_u32 s3, 4
    s_cbranch_scc0 L_vec
    s_add_u32 m0, s95, 0
    s_nop 0
    buffer_load_dwordx4 v1, s[8:11], s94 offen offset:0 lds
    s_add_u32 m0, s95, 3840
    s_nop 0
    buffer_load_dwordx4 v1, s[8:11], s94 offen offset:256 lds
    s_add_u32 m0, s95, 7680
    s_nop 0
    buffer_load_dwordx4 v1, s[8:11], s94 offen offset:512 lds
    s_add_u32 m0, s95, 11520
    s_nop 0
    buffer_load_dwordx4 v1, s[8:11], s94 offen offset:768 lds
    s_add_u32 m0, s95, 15360
    s_nop 0
    buffer_load_dwordx4 v1, s[8:11], s94 offen offset:1024 lds
    s_add_u32 m0, s96, 122880
    s_add_u32 s97, s96, 4096
    buffer_load_dwordx4 v5, s[16:19], s96 offen offset:0 lds
    buffer_load_dwordx4 v5, s[16:19], s96 offen offset:1024 lds
    buffer_load_dwordx4 v5, s[16:19], s96 offen offset:2048 lds
    buffer_load_dwordx4 v5, s[16:19], s96 offen offset:3072 lds
    s_add_u32 m0, s96, 126976
    s_cmp_eq_u32 s3, 7
    buffer_load_dwordx4 v5, s[16:19], s97 offen offset:0 lds
    buffer_load_dwordx4 v5, s[16:19], s97 offen offset:1024 lds
    s_cbranch_scc0 L_rest
    buffer_load_dwordx4 v5, s[16:19], s97 offen offset:2048 lds
    s_branch L_rest
L_vec:
    s_lshl_b32 s96, s5, 2
    s_and_b32 s96, s96, 4
    s_add_u32 s96, s96, s3
    s_sub_u32 s96, s96, 2
    s_cmp_lt_u32 s96, 2
    s_cbranch_scc0 L_rest
    s_cmp_eq_u32 s96, 0
    s_cselect_b64 s[16:17], s[68:69], s[76:77]
    s_movk_i32 s18, 1280
    s_mulk_i32 s96, 1280
    s_add_u32 m0, s96, 148480
    v_lshlrev_b32 v6, 2, v0
    buffer_load_dwordx4 v5, s[16:19], 0 offen lds
    buffer_load_dword v6, s[16:19], 0 offen offset:1024 lds
L_rest:
    s_mov_b64 s[12:13], s[58:59]
    s_mov_b64 s[20:21], s[64:65]
    s_mov_b64 s[32:33], s[70:71]
    s_mov_b64 s[36:37], s[72:73]
    s_mov_b64 s[40:41], s[74:75]
    s_mov_b64 s[44:45], s[78:79]
    s_mov_b64 s[48:49], s[80:81]
    s_mov_b64 s[52:53], s[82:83]
    s_mov_b32 s84, 0
    s_mov_b32 s90, 0
    v_lshlrev_b32 v6, 2, v0
    v_lshl_add_u32 v9, v7, 8, v9
    v_mov_b64 v[10:11], 0
    v_mov_b32 v226, 161280
    v_mov_b32 v227, 1
    v_lshl_add_u32 v12, v0, 3, v226
    ds_write_b64 v12, v[10:11]
    s_mov_b32 s14, 819200
    s_mov_b32 s15, s11
    s_mov_b32 s22, s14
    s_mov_b32 s23, s11
    s_mov_b32 s34, 2211840
    s_mov_b32 s35, s11
    s_mov_b32 s38, s34
    s_mov_b32 s39, s11
    s_mov_b32 s42, s34
    s_mov_b32 s43, s11
    s_mov_b32 s46, s10
    s_mov_b32 s47, s11
    s_mov_b32 s50, 256
    s_mov_b32 s51, s11
    s_mov_b32 s54, 3932160
    s_mov_b32 s55, s11
    s_cmp_ge_u32 s3, 4
    s_cbranch_scc0 L_cwaves
    s_barrier
    s_setprio 1
    s_lshl_b32 s93, s88, 6
    v_add_u32 v16, s94, v9
    v_xor_b32 v16, s93, v16
    v_lshrrev_b32 v17, 2, v7
    v_lshl_add_u32 v17, v8, 3, v17
    v_mul_u32_u24 v17, 40, v17
    s_mul_i32 s92, s88, 1280
    s_add_u32 s92, s92, 122880
    v_and_b32 v18, 3, v0
    s_bitcmp1_b32 s5, 0
    s_cselect_b32 s94, 3, 2
    s_cselect_b32 s95, 3, 4
    s_cselect_b32 s96, 32, 8
    v_min_u32 v18, s94, v18
    v_lshlrev_b32 v18, s95, v18
    v_add3_u32 v17, v17, v18, s92
    v_add_u32 v18, s96, v17
    s_lshl_b32 s92, s88, 11
    s_add_u32 s92, s92, 151040
    v_add_u32 v19, s92, v5
    v_and_b32 v25, 1, v0
    v_mul_u32_u24 v25, 1280, v25
    v_lshl_add_u32 v25, v8, 4, v25
    s_add_u32 s93, s93, 148480
    v_add_u32 v25, s93, v25
    v_lshrrev_b32 v26, 5, v0
    v_mul_u32_u24 v26, 192, v26
    v_sub_u32 v26, v5, v26
    s_lshr_b32 s95, s7, 1
    s_lshl1_add_u32 s94, s4, s95
    s_and_b32 s95, s7, 1
    s_and_b32 s96, s5, 1
    s_lshl1_add_u32 s95, s96, s95
    s_lshl2_add_u32 s58, s94, s95
    s_mul_i32 s58, s58, 640
    s_lshl_b32 s94, s94, 5
    s_add_u32 s94, s94, s95
    s_lshl_b32 s94, s94, 2
    s_add_u32 s57, s94, 163840
    s_movk_i32 s96, 1120
    s_movk_i32 s97, 5120
    v_mul_u32_u24 v10, 6554, v0
    v_lshrrev_b32 v11, 16, v10
    v_bfe_u32 v12, v10, 18, 1
    v_bfe_u32 v13, v10, 19, 1
    v_mad_u32_u24 v11, v11, s96, v5
    v_sub_u32 v12, v12, v13
    v_mad_i32_i24 v28, v12, s97, v11
    v_add_u32 v10, 419456, v10
    v_lshrrev_b32 v11, 16, v10
    v_bfe_u32 v12, v10, 18, 1
    v_bfe_u32 v13, v10, 19, 1
    v_mad_u32_u24 v11, v11, s96, v5
    v_sub_u32 v12, v12, v13
    v_mad_i32_i24 v29, v12, s97, v11
    v_add_u32 v10, 419456, v10
    v_lshrrev_b32 v11, 16, v10
    v_bfe_u32 v12, v10, 18, 1
    v_bfe_u32 v13, v10, 19, 1
    v_mad_u32_u24 v11, v11, s96, v5
    v_sub_u32 v12, v12, v13
    v_mad_i32_i24 v30, v12, s97, v11
    v_add_u32 v10, 419456, v10
    v_lshrrev_b32 v11, 16, v10
    v_bfe_u32 v12, v10, 18, 1
    v_bfe_u32 v13, v10, 19, 1
    v_mad_u32_u24 v11, v11, s96, v5
    v_sub_u32 v12, v12, v13
    v_mad_i32_i24 v31, v12, s97, v11
    v_add_u32 v10, 419456, v10
    v_lshrrev_b32 v11, 16, v10
    v_bfe_u32 v12, v10, 18, 1
    v_bfe_u32 v13, v10, 19, 1
    v_mad_u32_u24 v11, v11, s96, v5
    v_sub_u32 v12, v12, v13
    v_mad_i32_i24 v32, v12, s97, v11
    s_lshr_b32 s59, s4, 3
    s_add_u32 s59, s59, s5
    s_add_u32 s59, s59, 2
    s_mul_i32 s96, s59, 13
    s_lshr_b32 s96, s96, 6
    s_mul_i32 s96, s96, 5
    s_sub_u32 s59, s59, s96
    s_add_u32 s92, s7, 1
    s_and_b32 s92, s92, 3
    s_mul_i32 s92, s92, 20480
    s_add_u32 s93, s7, 2
    s_and_b32 s93, s93, 3
    s_mul_i32 s93, s93, 20480
    s_add_u32 s94, s7, 3
    s_and_b32 s94, s94, 3
    s_mul_i32 s94, s94, 20480
    s_mul_i32 s95, s88, 40960
    s_mul_i32 s96, s5, 160
    s_add_u32 s95, s95, s96
    s_mul_i32 s87, s88, 5120
    s_lshl_b32 s56, s88, 10
    s_bfe_u32 s85, s3, 0x10001
    s_and_b32 s96, s3, 1
    s_lshr_b32 s86, s3, 2
    s_lshl1_add_u32 s86, s86, s96
    s_lshl_b32 s96, s96, 1
    s_lshl2_add_u32 s101, s85, s96
    s_mov_b32 s98, 0x33ffff
    s_mov_b32 s99, 0x33ffff
    s_and_b32 s6, s2, 7
    s_lshr_b32 s100, s2, 6
    s_lshl3_add_u32 s6, s100, s6
    s_bfe_u32 s100, s2, 0x30003
    v_bfe_u32 v10, v0, 4, 1
    v_lshrrev_b32 v11, 5, v0
    v_mul_u32_u24 v10, 640, v10
    v_lshl_add_u32 v2, v11, 8, v10
    v_lshl_add_u32 v2, v7, 4, v2
    v_lshl_add_u32 v3, v11, 6, v10
    v_lshl_add_u32 v3, v7, 2, v3
    v_and_b32 v10, 19, v0
    v_bfe_u32 v12, v0, 2, 1
    v_bfe_u32 v13, v0, 3, 1
    v_lshl_or_b32 v10, v13, 2, v10
    v_bfe_u32 v13, v0, 4, 1
    v_lshlrev_b32 v13, 1, v13
    v_sub_u32 v13, 3, v13
    v_lshlrev_b32 v12, v13, v12
    v_add_u32 v10, v10, v12
    v_mul_u32_u24 v11, 320, v11
    v_lshl_add_u32 v4, v10, 4, v11
    v_mov_b32 v15, 0
    v_mov_b64 v[152:153], 0
    v_mov_b64 v[154:155], 0
    v_mov_b64 v[156:157], 0
    v_mov_b64 v[158:159], 0
    v_cmp_gt_u32 vcc, 32, v0
    v_mov_b32 v11, 0x3f803f80
    v_and_b32 v12, 27, v0
    v_mfma_f32_32x32x8_bf16 v[160:175], v[152:153], v[152:153], 0
    v_cndmask_b32 v57, 0, v11, vcc
    v_mfma_f32_32x32x8_bf16 v[176:191], v[152:153], v[152:153], 0
    v_cndmask_b32 v59, 0, v11, vcc
    v_mfma_f32_32x32x8_bf16 v[192:207], v[152:153], v[152:153], 0
    v_cndmask_b32 v61, 0, v11, vcc
    v_mfma_f32_32x32x8_bf16 v[208:223], v[152:153], v[152:153], 0
    v_cndmask_b32 v63, 0, v11, vcc
    v_cmp_eq_u32 vcc, 18, v12
    v_mov_b32 v14, 0xdddddddd
    s_nop 0
    v_cndmask_b32 v64, 0, v11, vcc
    v_cndmask_b32 v65, 0, v11, vcc
    v_mov_b64 v[66:67], v[64:65]
    v_mov_b64 v[68:69], v[64:65]
    v_mov_b64 v[70:71], v[64:65]
    v_mov_b64 v[72:73], v[64:65]
    v_mov_b64 v[74:75], v[64:65]
    v_mov_b64 v[76:77], v[64:65]
    v_mov_b64 v[78:79], v[64:65]
    v_mov_b64 v[80:81], v[64:65]
    v_mov_b64 v[82:83], v[64:65]
    v_mov_b64 v[84:85], v[64:65]
    v_mov_b64 v[86:87], v[64:65]
    v_mov_b64 v[88:89], v[64:65]
    v_mov_b64 v[90:91], v[64:65]
    v_mov_b64 v[92:93], v[64:65]
    v_mov_b64 v[94:95], v[64:65]
    s_mov_b64 s[36:37], s[52:53]
    s_mul_i32 s38, s86, 40960
    s_add_u32 s38, s38, 40960
    s_add_u32 s32, s52, 1048576
    s_addc_u32 s33, s53, 0
    s_mov_b32 s34, s46
    s_waitcnt vmcnt(0)
    s_barrier
    ds_read_b128 v[228:231], v16 offset:0
    ds_read_b64_tr_b16 v[96:97], v17 offset:0
    ds_read_b64_tr_b16 v[98:99], v17 offset:160
    ds_read_b64_tr_b16 v[100:101], v18 offset:0
    ds_read_b64_tr_b16 v[102:103], v18 offset:160
    ds_read_b128 v[232:235], v16 offset:4096
    ds_read_b64_tr_b16 v[104:105], v17 offset:5120
    ds_read_b64_tr_b16 v[106:107], v17 offset:5280
    ds_read_b64_tr_b16 v[108:109], v18 offset:5120
    ds_read_b64_tr_b16 v[110:111], v18 offset:5280
    ds_read_b128 v[236:239], v16 offset:8192
    ds_read_b64_tr_b16 v[112:113], v17 offset:10240
    ds_read_b64_tr_b16 v[114:115], v17 offset:10400
    ds_read_b64_tr_b16 v[116:117], v18 offset:10240
    ds_read_b64_tr_b16 v[118:119], v18 offset:10400
    ds_read_b128 v[240:243], v16 offset:12288
    ds_read_b64_tr_b16 v[120:121], v17 offset:15360
    ds_read_b64_tr_b16 v[122:123], v17 offset:15520
    ds_read_b64_tr_b16 v[124:125], v18 offset:15360
    ds_read_b64_tr_b16 v[126:127], v18 offset:15520
    ds_read_b128 v[244:247], v16 offset:16384
    ds_read_b64_tr_b16 v[128:129], v17 offset:20480
    ds_read_b64_tr_b16 v[130:131], v17 offset:20640
    ds_read_b64_tr_b16 v[132:133], v18 offset:20480
    ds_read_b64_tr_b16 v[134:135], v18 offset:20640
    s_bitcmp1_b32 s5, 0
    s_cbranch_scc1 L_kv_v
    s_mov_b32 exec_lo, 0x03000300
    s_mov_b32 exec_hi, 0x03000300
    ds_read_b128 v[100:103], v25 offset:0
    ds_read_b128 v[108:111], v25 offset:256
    ds_read_b128 v[116:119], v25 offset:512
    ds_read_b128 v[124:127], v25 offset:768
    ds_read_b128 v[132:135], v25 offset:1024
    s_mov_b64 exec, -1
    s_waitcnt lgkmcnt(15)
    v_mfma_f32_16x16x32_bf16 v[136:139], v[96:99], v[228:231], 0
    s_waitcnt lgkmcnt(15)
    v_mfma_f32_16x16x32_bf16 v[136:139], v[104:107], v[232:235], v[136:139]
    s_waitcnt lgkmcnt(15)
    v_mfma_f32_16x16x32_bf16 v[136:139], v[112:115], v[236:239], v[136:139]
    s_waitcnt lgkmcnt(12)
    v_mfma_f32_16x16x32_bf16 v[136:139], v[120:123], v[240:243], v[136:139]
    s_waitcnt lgkmcnt(7)
    v_mfma_f32_16x16x32_bf16 v[136:139], v[128:131], v[244:247], v[136:139]
    s_waitcnt lgkmcnt(4)
    v_mfma_f32_16x16x32_bf16 v[140:143], v[100:103], v[228:231], 0
    s_waitcnt lgkmcnt(3)
    v_mfma_f32_16x16x32_bf16 v[140:143], v[108:111], v[232:235], v[140:143]
    s_waitcnt lgkmcnt(2)
    v_mfma_f32_16x16x32_bf16 v[140:143], v[116:119], v[236:239], v[140:143]
    s_waitcnt lgkmcnt(1)
    v_mfma_f32_16x16x32_bf16 v[140:143], v[124:127], v[240:243], v[140:143]
    s_waitcnt lgkmcnt(0)
    v_mfma_f32_16x16x32_bf16 v[140:143], v[132:135], v[244:247], v[140:143]
    s_branch L_kv_j
L_kv_v:
    s_waitcnt lgkmcnt(15)
    v_mfma_f32_16x16x32_bf16 v[136:139], v[228:231], v[96:99], 0
    v_mfma_f32_16x16x32_bf16 v[140:143], v[228:231], v[100:103], 0
    s_waitcnt lgkmcnt(15)
    v_mfma_f32_16x16x32_bf16 v[136:139], v[232:235], v[104:107], v[136:139]
    v_mfma_f32_16x16x32_bf16 v[140:143], v[232:235], v[108:111], v[140:143]
    s_waitcnt lgkmcnt(10)
    v_mfma_f32_16x16x32_bf16 v[136:139], v[236:239], v[112:115], v[136:139]
    v_mfma_f32_16x16x32_bf16 v[140:143], v[236:239], v[116:119], v[140:143]
    s_waitcnt lgkmcnt(5)
    v_mfma_f32_16x16x32_bf16 v[136:139], v[240:243], v[120:123], v[136:139]
    v_mfma_f32_16x16x32_bf16 v[140:143], v[240:243], v[124:127], v[140:143]
    s_waitcnt lgkmcnt(0)
    v_mfma_f32_16x16x32_bf16 v[136:139], v[244:247], v[128:131], v[136:139]
    v_mfma_f32_16x16x32_bf16 v[140:143], v[244:247], v[132:135], v[140:143]
L_kv_j:
    s_cmp_eq_u32 s3, 4
    s_cbranch_scc1 L_kv_fin
    s_nop 5
    ds_write_b128 v19, v[136:139]
    ds_write_b128 v19, v[140:143] offset:1024
    s_waitcnt lgkmcnt(0)
    s_barrier
    s_branch L_hq
L_kv_fin:
    v_cmp_eq_u32 vcc, 3, v8
    s_barrier
    ds_read_b128 v[96:99], v19 offset:2048
    ds_read_b128 v[100:103], v19 offset:3072
    ds_read_b128 v[104:107], v19 offset:4096
    ds_read_b128 v[108:111], v19 offset:5120
    ds_read_b128 v[112:115], v19 offset:6144
    ds_read_b128 v[116:119], v19 offset:7168
    s_waitcnt lgkmcnt(4)
    v_pk_add_f32 v[136:137], v[136:137], v[96:97]
    v_pk_add_f32 v[138:139], v[138:139], v[98:99]
    v_pk_add_f32 v[140:141], v[140:141], v[100:101]
    v_pk_add_f32 v[142:143], v[142:143], v[102:103]
    s_waitcnt lgkmcnt(2)
    v_pk_add_f32 v[136:137], v[136:137], v[104:105]
    v_pk_add_f32 v[138:139], v[138:139], v[106:107]
    v_pk_add_f32 v[140:141], v[140:141], v[108:109]
    v_pk_add_f32 v[142:143], v[142:143], v[110:111]
    s_waitcnt lgkmcnt(0)
    v_pk_add_f32 v[136:137], v[136:137], v[112:113]
    v_pk_add_f32 v[138:139], v[138:139], v[114:115]
    v_pk_add_f32 v[140:141], v[140:141], v[116:117]
    v_pk_add_f32 v[142:143], v[142:143], v[118:119]
    v_cvt_pk_bf16_f32 v96, v136, v137
    v_cvt_pk_bf16_f32 v97, v138, v139
    v_cvt_pk_bf16_f32 v98, v140, v141
    v_cvt_pk_bf16_f32 v99, v142, v143
    s_bitcmp1_b32 s5, 0
    s_cbranch_scc1 L_kv_sv
    v_cndmask_b32 v100, v96, v97, vcc
    s_mov_b32 exec_hi, 0
    buffer_store_dwordx4 v[96:99], v5, s[52:55], s58 offen sc1
    s_not_b64 exec, exec
    buffer_store_dword v100, v6, s[52:55], s58 offen offset:384 sc1
    s_mov_b32 exec_hi, 0xffff
    s_lshl2_add_u32 s58, s4, s7
    s_lshl_b32 s96, s58, 6
    s_add_u32 s96, s96, 819072
    v_mov_b32 v10, v140
    buffer_store_dword v141, v6, s[52:55], s96 offen sc1
    s_nop 0
    v_max_f32_dpp v10, v10, v10 row_ror:1 row_mask:0xf bank_mask:0xf
    s_nop 1
    v_max_f32_dpp v10, v10, v10 row_ror:2 row_mask:0xf bank_mask:0xf
    s_nop 1
    v_max_f32_dpp v10, v10, v10 row_ror:4 row_mask:0xf bank_mask:0xf
    s_nop 1
    v_max_f32_dpp v10, v10, v10 row_ror:8 row_mask:0xf bank_mask:0xf
    v_cmp_eq_f32 vcc, v10, v140
    s_lshl_b32 s96, s58, 3
    s_ff1_i32_b64 s97, vcc
    s_and_b32 s97, s97, 15
    s_lshl1_add_u32 s97, s96, s97
    s_add_u32 s96, s96, 172032
    v_mov_b32 v11, s97
    s_mov_b32 exec_hi, 1
    buffer_store_dwordx2 v[10:11], off, s[52:55], s96 sc1
    s_branch L_kv_fl
L_kv_sv:
    v_permlane16_swap_b32 v96, v98
    v_permlane16_swap_b32 v97, v99
    s_mov_b32 exec_lo, 0xfffff
    s_mov_b32 exec_hi, 0xfffff
    buffer_store_dwordx4 v[96:99], v26, s[52:55], s58 offen sc1
L_kv_fl:
    s_mov_b64 exec, -1
L_hq:
    s_barrier
    s_buffer_load_dword s84, s[48:51], 0
    s_barrier
    s_cmp_eq_u32 s3, 4
    s_cbranch_scc0 L_noflag
    s_waitcnt vmcnt(0) lgkmcnt(0)
    s_cmp_lg_u32 s84, 0
    s_cbranch_scc0 L_nz_1
L_nzd_3:
    s_getreg_b32 s97, hwreg(HW_REG_XCC_ID, 0, 4)
    s_or_b32 s97, s97, s84
    v_mov_b32 v10, s97
    s_mov_b64 exec, 1
    buffer_store_dword v10, off, s[52:55], s57 sc1
    s_mov_b64 exec, -1
L_noflag:
    s_mul_i32 s96, s59, 3840
    s_add_u32 s96, s96, s56
    s_lshl_b32 s91, s59, 8
    s_add_u32 s97, s92, s91
    s_add_u32 m0, s97, s96
    s_nop 0
    buffer_load_dwordx4 v1, s[8:11], s97 offen lds
    s_add_u32 s97, s93, s91
    s_add_u32 m0, s97, s96
    s_nop 0
    buffer_load_dwordx4 v1, s[8:11], s97 offen lds
    s_add_u32 s97, s94, s91
    s_add_u32 m0, s97, s96
    s_nop 0
    buffer_load_dwordx4 v1, s[8:11], s97 offen lds
    s_add_u32 m0, s87, 122880
    s_mul_i32 s96, s59, 163840
    s_add_u32 s96, s96, s95
    buffer_load_dwordx4 v28, s[12:15], s96 offen offset:0 lds
    buffer_load_dwordx4 v29, s[12:15], s96 offen offset:1024 lds
    buffer_load_dwordx4 v30, s[12:15], s96 offen offset:2048 lds
    buffer_load_dwordx4 v31, s[12:15], s96 offen offset:3072 lds
    s_add_u32 m0, s87, 126976
    s_add_u32 s96, s96, 4096
    buffer_load_dwordx4 v32, s[12:15], s96 offen lds
    s_add_u32 s59, s59, 1
    s_cmp_eq_u32 s59, 5
    s_cselect_b32 s59, 0, s59
    s_sub_u32 s96, s3, 3
    s_lshl_b32 s26, s96, 10
    s_lshl_b32 s96, s96, 6
    v_add_u32 v10, s96, v0
    v_mul_u32_u24 v13, 6554, v10
    v_lshrrev_b32 v13, 16, v13
    v_mul_u32_u24 v11, 10, v13
    v_sub_u32 v12, v10, v11
    v_and_b32 v11, 19, v13
    v_bfe_u32 v10, v13, 2, 1
    v_lshl_or_b32 v11, v10, 3, v11
    v_bfe_u32 v10, v13, 3, 1
    v_lshl_or_b32 v11, v10, 2, v11
    v_lshrrev_b32 v10, 4, v11
    v_lshl_add_u32 v13, v10, 2, v11
    v_mul_u32_u24 v13, 1280, v13
    v_lshl_add_u32 v224, v12, 4, v13
    v_bfe_u32 v13, v11, 1, 2
    v_lshl_add_u32 v13, v10, 2, v13
    v_mul_u32_u24 v13, 20, v13
    v_bfe_u32 v10, v11, 3, 1
    v_lshl_add_u32 v13, v10, 1, v13
    v_and_b32 v10, 1, v11
    v_add3_u32 v13, v13, v10, 16
    v_mul_u32_u24 v13, 1280, v13
    v_lshl_add_u32 v225, v12, 4, v13
    s_mov_b64 s[16:17], s[20:21]
    s_mov_b32 s18, 819200
    s_mov_b32 s28, 5120
    s_mov_b32 s27, 51200
    s_mov_b32 s30, -768000
    s_lshl_b32 s29, s5, 1
    s_mul_i32 s25, s5, 102560
    s_mov_b32 s24, 16
    v_and_b32 v10, 3, v0
    v_lshrrev_b32 v254, 2, v7
    v_mul_u32_u24 v254, 1280, v254
    v_lshl_add_u32 v254, v8, 5, v254
    v_lshl_add_u32 v254, v10, 3, v254
    s_min_u32 s96, s88, 1
    s_lshl1_add_u32 s96, s88, s96
    s_lshl_b32 s96, s96, 7
    s_add_u32 s97, s96, 151040
    v_add_u32 v254, s97, v254
    s_lshl_b32 s96, s96, 1
    v_lshl_add_u32 v253, v7, 4, s96
    v_lshl_add_u32 v253, v8, 6, v253
    s_waitcnt lgkmcnt(0)
    s_barrier
    s_mul_i32 s96, s59, 3840
    s_add_u32 s96, s96, s56
    s_lshl_b32 s91, s59, 8
    s_add_u32 s97, s92, s91
    s_add_u32 m0, s97, s96
    s_nop 0
    buffer_load_dwordx4 v1, s[8:11], s97 offen lds
    s_add_u32 s97, s93, s91
    s_add_u32 m0, s97, s96
    s_nop 0
    buffer_load_dwordx4 v1, s[8:11], s97 offen lds
    s_add_u32 s97, s94, s91
    s_add_u32 m0, s97, s96
    s_nop 0
    buffer_load_dwordx4 v1, s[8:11], s97 offen lds
    s_add_u32 m0, s87, 81920
    s_mul_i32 s96, s59, 163840
    s_add_u32 s96, s96, s95
    buffer_load_dwordx4 v28, s[12:15], s96 offen offset:0 lds
    buffer_load_dwordx4 v29, s[12:15], s96 offen offset:1024 lds
    buffer_load_dwordx4 v30, s[12:15], s96 offen offset:2048 lds
    buffer_load_dwordx4 v31, s[12:15], s96 offen offset:3072 lds
    s_add_u32 m0, s87, 86016
    s_add_u32 s96, s96, 4096
    buffer_load_dwordx4 v32, s[12:15], s96 offen lds
    s_add_u32 s59, s59, 1
    s_cmp_eq_u32 s59, 5
    s_cselect_b32 s59, 0, s59
    s_mul_i32 s96, s101, 1280
    s_add_u32 s96, s96, 151040
    v_add_u32 v236, s96, v5
    v_add_u32 v238, s96, v6
    s_xor_b32 s96, s101, 2
    s_mul_i32 s96, s96, 1280
    s_add_u32 s96, s96, 151040
    v_add_u32 v237, s96, v5
    v_add_u32 v239, s96, v6
    s_lshl_b32 s96, s101, 7
    s_xor_b32 s97, s96, 256
    s_add_u32 s96, s96, 161792
    s_add_u32 s97, s97, 161792
    v_add_u32 v240, s96, v6
    v_and_b32 v242, 124, v6
    v_add_u32 v241, s96, v242
    v_add_u32 v242, s97, v242
    s_and_b32 s96, s3, 3
    s_xor_b32 s97, s3, 1
    s_mul_i32 s96, s96, 6144
    s_mul_i32 s97, s97, 6144
    s_add_u32 s96, s96, 102400
    s_add_u32 s97, s97, 102400
    v_add_u32 v252, s97, v5
    v_add_u32 v255, s96, v5
    s_waitcnt vmcnt(8)
    s_barrier
    s_mul_i32 s96, s59, 3840
    s_add_u32 s96, s96, s56
    s_lshl_b32 s91, s59, 8
    s_add_u32 s97, s92, s91
    s_add_u32 m0, s97, s96
    s_nop 0
    buffer_load_dwordx4 v1, s[8:11], s97 offen lds
    s_add_u32 s97, s93, s91
    s_add_u32 m0, s97, s96
    s_nop 0
    buffer_load_dwordx4 v1, s[8:11], s97 offen lds
    s_add_u32 s97, s94, s91
    s_add_u32 m0, s97, s96
    s_nop 0
    buffer_load_dwordx4 v1, s[8:11], s97 offen lds
    s_add_u32 m0, s87, 102400
    s_mul_i32 s96, s59, 163840
    s_add_u32 s96, s96, s95
    buffer_load_dwordx4 v28, s[12:15], s96 offen offset:0 lds
    buffer_load_dwordx4 v29, s[12:15], s96 offen offset:1024 lds
    buffer_load_dwordx4 v30, s[12:15], s96 offen offset:2048 lds
    buffer_load_dwordx4 v31, s[12:15], s96 offen offset:3072 lds
    s_add_u32 m0, s87, 106496
    s_add_u32 s96, s96, 4096
    buffer_load_dwordx4 v32, s[12:15], s96 offen lds
    s_add_u32 s59, s59, 1
    s_cmp_eq_u32 s59, 5
    s_cselect_b32 s59, 0, s59
    v_lshrrev_b32 v10, 2, v0
    v_lshlrev_b32 v10, 7, v10
    v_and_or_b32 v10, v6, 12, v10
    s_lshl_b32 s92, s88, 11
    s_add_u32 s92, s92, 163840
    s_waitcnt vmcnt(8)
    s_barrier
    s_cmp_lg_u32 s84, 0
    s_cbranch_scc0 L_nz_4
L_nzd_6:
    buffer_load_dword v11, v10, s[52:55], s92 offen sc1
    s_mov_b32 s40, 0
    s_lshl2_add_u32 s94, s4, s85
    s_add_u32 s94, s94, s85
    s_mul_i32 s94, s94, 20480
    s_andn2_b32 s93, 2, s101
    s_lshl_b32 s13, s5, 9
    s_lshl2_add_u32 s13, s93, s13
    s_lshl2_add_u32 s93, s5, s93
    s_lshl_b32 s93, s93, 9
    s_add_u32 s12, s93, s94
    s_add_u32 s13, s13, s94
    s_add_u32 s13, s13, 16384
    s_lshl3_add_u32 s95, s4, s5
    s_lshl2_add_u32 s95, s95, s3
    s_lshl_b32 s95, s95, 2
    s_add_u32 s14, s95, 196592
    v_bfe_u32 v12, v0, 4, 1
    v_mul_u32_u24 v13, 19840, v12
    v_add_u32 v1, v2, v13
    v_bfe_u32 v12, v0, 2, 1
    v_lshl_add_u32 v12, v8, 1, v12
    v_and_b32 v13, 0x2c, v6
    v_lshl_add_u32 v251, v12, 6, v13
    v_cmp_eq_u32 vcc, v7, v8
    v_mov_b32 v248, 1.0
    v_lshl_add_u32 v249, v0, 1, v226
    v_cndmask_b32 v13, 16, 0, vcc
    v_add_u32 v250, v13, v226
    v_and_b32 v15, 0x8c, v10
    s_lshl_b32 s93, s4, 8
    s_add_u32 s93, s93, 163840
    s_waitcnt vmcnt(0)
    v_and_b32 v11, -16, v11
    v_cmp_eq_u32 vcc, s84, v11
    s_nop 0
    s_cmp_eq_u64 vcc, -1
    s_cbranch_scc0 L_retry_7
L_pdone_9:
    s_barrier
    s_cmp_eq_u32 s3, 7
    s_cbranch_scc0 L_norc
    s_mov_b32 s92, 172032
    buffer_load_dwordx4 v[10:13], v5, s[52:55], s92 offen sc1
L_norc:
    s_mul_i32 s87, s86, 40960
    buffer_load_dwordx4 v[40:43], v2, s[36:39], s87 offen
    buffer_load_dword v56, v3, s[36:39], s87 offen offset:512
    s_mul_i32 s97, s86, 16
    s_bitset1_b32 s97, 0
    s_mul_i32 s97, s97, 2560
    buffer_load_dwordx4 v[44:47], v2, s[36:39], s97 offen
    buffer_load_dword v58, v3, s[36:39], s97 offen offset:512
    buffer_load_dword v15, v15, s[52:55], s93 offen sc1
    v_mov_b32 v21, 0
    v_mov_b32 v27, 0
    s_mov_b64 exec, s[98:99]
    buffer_load_dwordx4 v[64:67], v4, s[36:39], s87 offen offset:1280
    buffer_load_dwordx4 v[80:83], v4, s[36:39], s87 offen offset:1920
    s_mov_b64 exec, -1
    s_add_u32 s87, s87, 2560
    s_mov_b64 exec, s[98:99]
    buffer_load_dwordx4 v[68:71], v4, s[36:39], s87 offen offset:1280
    buffer_load_dwordx4 v[84:87], v4, s[36:39], s87 offen offset:1920
    s_mov_b64 exec, -1
    s_add_u32 s87, s87, 2560
    buffer_load_dwordx4 v[48:51], v2, s[36:39], s87 offen
    buffer_load_dword v60, v3, s[36:39], s87 offen offset:512
    s_cmp_eq_u32 s3, 7
    s_cbranch_scc0 L_qdone
    s_waitcnt vmcnt(11)
    v_cmp_gt_f32 vcc, v12, v10
    s_nop 1
    v_cndmask_b32 v10, v10, v12, vcc
    v_cndmask_b32 v11, v11, v13, vcc
    v_mov_b32 v12, v10
    s_nop 1
    v_max_f32_dpp v12, v12, v12 row_ror:1 row_mask:0xf bank_mask:0xf
    s_nop 1
    v_max_f32_dpp v12, v12, v12 row_ror:2 row_mask:0xf bank_mask:0xf
    s_nop 1
    v_max_f32_dpp v12, v12, v12 row_ror:4 row_mask:0xf bank_mask:0xf
    s_nop 1
    v_max_f32_dpp v12, v12, v12 row_ror:8 row_mask:0xf bank_mask:0xf
    v_mov_b32 v13, v12
    s_nop 1
    v_permlane16_swap_b32 v12, v13
    v_max_f32 v12, v12, v13
    v_mov_b32 v13, v12
    s_nop 1
    v_permlane32_swap_b32 v12, v13
    v_max_f32 v12, v12, v13
    v_cmp_eq_f32 vcc, v12, v10
    s_nop 0
    s_ff1_i32_b64 s92, vcc
    s_and_b32 s92, s92, 63
    v_readlane_b32 s56, v11, s92
    s_nop 0
    s_and_b32 s56, s56, 2047
    v_mov_b32 v13, s56
    ds_write_b64 v226, v[12:13] offset:16
    s_branch L_qdone
    s_nop 0
    s_nop 0
    s_nop 0
    s_nop 0
L_cwaves:
    s_or_b32 s94, s2, s3
    s_cmp_eq_u32 s94, 0
    s_cbranch_scc0 L_nononce
    s_lshr_b32 s93, s92, 27
    s_mul_i32 s93, s93, 0x2f0b57
    s_xor_b32 s92, s92, s93
    s_lshl_b32 s92, s92, 5
    s_or_b32 s92, s92, 16
    v_mov_b32 v10, s92
    s_mov_b64 exec, 1
    buffer_store_dword v10, off, s[48:51], 0 sc1
    s_mov_b64 exec, -1
L_nononce:
    s_movk_i32 s96, 1120
    s_movk_i32 s97, 5120
    v_mul_u32_u24 v10, 6554, v0
    v_lshrrev_b32 v11, 16, v10
    v_bfe_u32 v12, v10, 18, 1
    v_bfe_u32 v13, v10, 19, 1
    v_mad_u32_u24 v11, v11, s96, v5
    v_sub_u32 v12, v12, v13
    v_mad_i32_i24 v28, v12, s97, v11
    v_add_u32 v10, 419456, v10
    v_lshrrev_b32 v11, 16, v10
    v_bfe_u32 v12, v10, 18, 1
    v_bfe_u32 v13, v10, 19, 1
    v_mad_u32_u24 v11, v11, s96, v5
    v_sub_u32 v12, v12, v13
    v_mad_i32_i24 v29, v12, s97, v11
    v_add_u32 v10, 419456, v10
    v_lshrrev_b32 v11, 16, v10
    v_bfe_u32 v12, v10, 18, 1
    v_bfe_u32 v13, v10, 19, 1
    v_mad_u32_u24 v11, v11, s96, v5
    v_sub_u32 v12, v12, v13
    v_mad_i32_i24 v30, v12, s97, v11
    v_add_u32 v10, 419456, v10
    v_lshrrev_b32 v11, 16, v10
    v_bfe_u32 v12, v10, 18, 1
    v_bfe_u32 v13, v10, 19, 1
    v_mad_u32_u24 v11, v11, s96, v5
    v_sub_u32 v12, v12, v13
    v_mad_i32_i24 v31, v12, s97, v11
    v_add_u32 v10, 419456, v10
    v_lshrrev_b32 v11, 16, v10
    v_bfe_u32 v12, v10, 18, 1
    v_bfe_u32 v13, v10, 19, 1
    v_mad_u32_u24 v11, v11, s96, v5
    v_sub_u32 v12, v12, v13
    v_mad_i32_i24 v32, v12, s97, v11
    s_lshr_b32 s59, s4, 3
    s_add_u32 s59, s59, s5
    s_add_u32 s59, s59, 0
    s_mul_i32 s96, s59, 13
    s_lshr_b32 s96, s96, 6
    s_mul_i32 s96, s96, 5
    s_sub_u32 s59, s59, s96
    s_add_u32 s92, s7, 1
    s_and_b32 s92, s92, 3
    s_mul_i32 s92, s92, 20480
    s_add_u32 s93, s7, 2
    s_and_b32 s93, s93, 3
    s_mul_i32 s93, s93, 20480
    s_add_u32 s94, s7, 3
    s_and_b32 s94, s94, 3
    s_mul_i32 s94, s94, 20480
    s_mul_i32 s95, s88, 40960
    s_mul_i32 s96, s5, 160
    s_add_u32 s95, s95, s96
    s_mul_i32 s87, s88, 5120
    s_lshl_b32 s56, s88, 10
    s_mov_b32 s57, s59
    s_barrier
    s_cmp_eq_u32 s3, 1
    s_cbranch_scc0 L_notouch
    s_mul_i32 s58, s2, 3200
    v_min_u32 v10, 24, v0
    v_lshlrev_b32 v10, 7, v10
    buffer_load_dword v251, v10, s[12:15], s58 offen
L_notouch:
    s_bfe_u32 s85, s3, 0x10001
    s_and_b32 s96, s3, 1
    s_lshr_b32 s86, s3, 2
    s_lshl1_add_u32 s86, s86, s96
    s_lshl_b32 s96, s96, 1
    s_lshl2_add_u32 s101, s85, s96
    s_mov_b32 s98, 0x33ffff
    s_mov_b32 s99, 0x33ffff
    s_and_b32 s6, s2, 7
    s_lshr_b32 s100, s2, 6
    s_lshl3_add_u32 s6, s100, s6
    s_bfe_u32 s100, s2, 0x30003
    v_bfe_u32 v10, v0, 4, 1
    v_lshrrev_b32 v11, 5, v0
    v_mul_u32_u24 v10, 640, v10
    v_lshl_add_u32 v2, v11, 8, v10
    v_lshl_add_u32 v2, v7, 4, v2
    v_lshl_add_u32 v3, v11, 6, v10
    v_lshl_add_u32 v3, v7, 2, v3
    v_and_b32 v10, 19, v0
    v_bfe_u32 v12, v0, 2, 1
    v_bfe_u32 v13, v0, 3, 1
    v_lshl_or_b32 v10, v13, 2, v10
    v_bfe_u32 v13, v0, 4, 1
    v_lshlrev_b32 v13, 1, v13
    v_sub_u32 v13, 3, v13
    v_lshlrev_b32 v12, v13, v12
    v_add_u32 v10, v10, v12
    v_mul_u32_u24 v11, 320, v11
    v_lshl_add_u32 v4, v10, 4, v11
    v_mov_b32 v15, 0
    v_mov_b64 v[152:153], 0
    v_mov_b64 v[154:155], 0
    v_mov_b64 v[156:157], 0
    v_mov_b64 v[158:159], 0
    v_cmp_gt_u32 vcc, 32, v0
    v_mov_b32 v11, 0x3f803f80
    v_and_b32 v12, 27, v0
    v_mfma_f32_32x32x8_bf16 v[160:175], v[152:153], v[152:153], 0
    v_cndmask_b32 v57, 0, v11, vcc
    v_mfma_f32_32x32x8_bf16 v[176:191], v[152:153], v[152:153], 0
    v_cndmask_b32 v59, 0, v11, vcc
    v_mfma_f32_32x32x8_bf16 v[192:207], v[152:153], v[152:153], 0
    v_cndmask_b32 v61, 0, v11, vcc
    v_mfma_f32_32x32x8_bf16 v[208:223], v[152:153], v[152:153], 0
    v_cndmask_b32 v63, 0, v11, vcc
    v_cmp_eq_u32 vcc, 18, v12
    v_mov_b32 v14, 0xdddddddd
    s_nop 0
    v_cndmask_b32 v64, 0, v11, vcc
    v_cndmask_b32 v65, 0, v11, vcc
    v_mov_b64 v[66:67], v[64:65]
    v_mov_b64 v[68:69], v[64:65]
    v_mov_b64 v[70:71], v[64:65]
    v_mov_b64 v[72:73], v[64:65]
    v_mov_b64 v[74:75], v[64:65]
    v_mov_b64 v[76:77], v[64:65]
    v_mov_b64 v[78:79], v[64:65]
    v_mov_b64 v[80:81], v[64:65]
    v_mov_b64 v[82:83], v[64:65]
    v_mov_b64 v[84:85], v[64:65]
    v_mov_b64 v[86:87], v[64:65]
    v_mov_b64 v[88:89], v[64:65]
    v_mov_b64 v[90:91], v[64:65]
    v_mov_b64 v[92:93], v[64:65]
    v_mov_b64 v[94:95], v[64:65]
    s_cmp_eq_u32 s3, 3
    s_cbranch_scc1 L_jwo
    s_cmp_lt_u32 s6, 27
    s_cselect_b32 s24, 10, 0
    s_mov_b32 s18, 2211840
    s_mov_b32 s28, 1024
    s_mov_b32 s29, 64
    v_mov_b32 v225, 0
    s_cmp_eq_u32 s3, 2
    s_cbranch_scc1 L_jwd
    s_cmp_eq_u32 s3, 0
    s_cselect_b64 s[16:17], s[32:33], s[36:37]
    s_cselect_b32 s26, 0, 10304
    s_add_u32 s26, s26, 124928
    s_mov_b32 s27, 27648
    s_lshl_b32 s25, s6, 7
    s_mul_i32 s96, s100, 276480
    s_add_u32 s25, s25, s96
    v_lshrrev_b32 v10, 3, v0
    v_mul_u32_u24 v10, 3328, v10
    v_add_u32 v224, v5, v10
    s_branch L_jset
L_jwd:
    s_mov_b64 s[16:17], s[40:41]
    s_mov_b32 s26, 151040
    s_mov_b32 s27, 1024
    s_lshl3_add_u32 s25, s6, s100
    s_mul_i32 s25, s25, 10240
    v_mov_b32 v224, v5
    s_branch L_jset
L_jwo:
    s_sub_u32 s96, s3, 3
    s_lshl_b32 s26, s96, 10
    s_lshl_b32 s96, s96, 6
    v_add_u32 v10, s96, v0
    v_mul_u32_u24 v13, 6554, v10
    v_lshrrev_b32 v13, 16, v13
    v_mul_u32_u24 v11, 10, v13
    v_sub_u32 v12, v10, v11
    v_and_b32 v11, 19, v13
    v_bfe_u32 v10, v13, 2, 1
    v_lshl_or_b32 v11, v10, 3, v11
    v_bfe_u32 v10, v13, 3, 1
    v_lshl_or_b32 v11, v10, 2, v11
    v_lshrrev_b32 v10, 4, v11
    v_lshl_add_u32 v13, v10, 2, v11
    v_mul_u32_u24 v13, 1280, v13
    v_lshl_add_u32 v224, v12, 4, v13
    v_bfe_u32 v13, v11, 1, 2
    v_lshl_add_u32 v13, v10, 2, v13
    v_mul_u32_u24 v13, 20, v13
    v_bfe_u32 v10, v11, 3, 1
    v_lshl_add_u32 v13, v10, 1, v13
    v_and_b32 v10, 1, v11
    v_add3_u32 v13, v13, v10, 16
    v_mul_u32_u24 v13, 1280, v13
    v_lshl_add_u32 v225, v12, 4, v13
    s_mov_b64 s[16:17], s[20:21]
    s_mov_b32 s18, 819200
    s_mov_b32 s28, 5120
    s_mov_b32 s27, 51200
    s_mov_b32 s30, -768000
    s_lshl_b32 s29, s5, 1
    s_mul_i32 s25, s5, 102560
    s_mov_b32 s24, 16
L_jset:
    s_mov_b64 s[36:37], s[52:53]
    s_mul_i32 s38, s86, 40960
    s_add_u32 s38, s38, 40960
    s_add_u32 s32, s52, 1048576
    s_addc_u32 s33, s53, 0
    s_mov_b32 s34, s46
    s_mul_i32 s96, s59, 3840
    s_add_u32 s96, s96, s56
    s_lshl_b32 s91, s59, 8
    s_add_u32 s97, s92, s91
    s_add_u32 m0, s97, s96
    s_nop 0
    buffer_load_dwordx4 v1, s[8:11], s97 offen lds
    s_add_u32 s97, s93, s91
    s_add_u32 m0, s97, s96
    s_nop 0
    buffer_load_dwordx4 v1, s[8:11], s97 offen lds
    s_add_u32 s97, s94, s91
    s_add_u32 m0, s97, s96
    s_nop 0
    buffer_load_dwordx4 v1, s[8:11], s97 offen lds
    s_add_u32 m0, s87, 81920
    s_mul_i32 s96, s59, 163840
    s_add_u32 s96, s96, s95
    buffer_load_dwordx4 v28, s[12:15], s96 offen offset:0 lds
    buffer_load_dwordx4 v29, s[12:15], s96 offen offset:1024 lds
    buffer_load_dwordx4 v30, s[12:15], s96 offen offset:2048 lds
    buffer_load_dwordx4 v31, s[12:15], s96 offen offset:3072 lds
    s_add_u32 m0, s87, 86016
    s_add_u32 s96, s96, 4096
    buffer_load_dwordx4 v32, s[12:15], s96 offen lds
    s_add_u32 s59, s59, 1
    s_cmp_eq_u32 s59, 5
    s_cselect_b32 s59, 0, s59
    s_cmp_lt_u32 s3, 2
    s_cbranch_scc1 L_nov
    s_waitcnt vmcnt(8)
L_nov:
    s_barrier
    s_mul_i32 s96, s101, 1280
    s_add_u32 s96, s96, 151040
    v_add_u32 v236, s96, v5
    v_add_u32 v238, s96, v6
    s_xor_b32 s96, s101, 2
    s_mul_i32 s96, s96, 1280
    s_add_u32 s96, s96, 151040
    v_add_u32 v237, s96, v5
    v_add_u32 v239, s96, v6
    s_lshl_b32 s96, s101, 7
    s_xor_b32 s97, s96, 256
    s_add_u32 s96, s96, 161792
    s_add_u32 s97, s97, 161792
    v_add_u32 v240, s96, v6
    v_and_b32 v242, 124, v6
    v_add_u32 v241, s96, v242
    v_add_u32 v242, s97, v242
    s_mul_i32 s96, s3, 5
    s_add_u32 s96, s96, s57
    s_lshl_b32 s96, s96, 12
    v_add_u32 v10, s96, v9
    v_xor_b32 v11, 64, v10
    v_xor_b32 v12, 128, v10
    v_xor_b32 v13, 192, v10
    v_lshrrev_b32 v16, 5, v0
    v_lshlrev_b32 v16, 4, v16
    v_bfe_u32 v15, v0, 2, 3
    v_add_u32 v16, v16, v15
    v_and_b32 v15, 3, v0
    v_lshl_add_u32 v16, v16, 2, v15
    v_mul_u32_u24 v16, 40, v16
    v_mov_b64 v[96:97], 0
    v_mov_b64 v[98:99], 0
    v_mov_b64 v[100:101], 0
    v_mov_b64 v[102:103], 0
    v_mov_b64 v[104:105], 0
    v_mov_b64 v[106:107], 0
    v_mov_b64 v[108:109], 0
    v_mov_b64 v[110:111], 0
    v_mov_b64 v[112:113], 0
    v_mov_b64 v[114:115], 0
    s_barrier
    s_buffer_load_dword s84, s[48:51], 0
    s_and_b32 s96, s3, 3
    s_xor_b32 s97, s3, 1
    s_mul_i32 s96, s96, 6144
    s_mul_i32 s97, s97, 6144
    s_add_u32 s96, s96, 102400
    s_add_u32 s97, s97, 102400
    v_add_u32 v252, s97, v5
    v_add_u32 v253, s96, v5
    v_and_b32 v15, 3, v0
    v_lshrrev_b32 v19, 2, v0
    v_lshlrev_b32 v19, 7, v19
    v_lshl_add_u32 v19, v15, 3, v19
    s_lshl_b32 s96, s3, 5
    s_add_u32 s96, s96, 124928
    v_add_u32 v19, s96, v19
    s_mul_i32 s96, s100, 160
    s_add_u32 s96, s96, 145536
    v_mov_b32 v15, 161536
    v_mov_b32 v17, s96
    v_lshrrev_b32 v18, 1, v7
    v_cmp_eq_u32 vcc, 0, v18
    v_cmp_eq_u32 s[0:1], 1, v18
    v_lshrrev_b32 v255, 5, v0
    v_cndmask_b32 v9, v15, v17, vcc
    v_cndmask_b32 v254, v15, v17, s[0:1]
    v_lshl_add_u32 v9, v8, 3, v9
    v_lshl_add_u32 v254, v8, 3, v254
    v_lshlrev_b32 v255, 10, v255
    v_lshl_add_u32 v255, v7, 4, v255
    v_and_b32 v15, 1, v8
    v_lshl_add_u32 v255, v15, 6, v255
    s_mul_i32 s96, s85, 5120
    s_add_u32 s96, s96, 151040
    s_and_b32 s97, s3, 1
    s_lshl_b32 s97, s97, 4
    v_mul_u32_u24 v15, 1280, v8
    v_add_u32 v15, s96, v15
    v_add_u32 v17, s97, v7
    v_lshl_add_u32 v18, v17, 2, v15
    v_lshl_add_u32 v17, v17, 4, v15
    v_add_u32 v18, 1024, v18
    v_mov_b32 v26, 0x3ea52b5c
    s_barrier
    s_mul_i32 s96, s59, 3840
    s_add_u32 s96, s96, s56
    s_lshl_b32 s91, s59, 8
    s_add_u32 s97, s92, s91
    s_add_u32 m0, s97, s96
    s_nop 0
    buffer_load_dwordx4 v1, s[8:11], s97 offen lds
    s_add_u32 s97, s93, s91
    s_add_u32 m0, s97, s96
    s_nop 0
    buffer_load_dwordx4 v1, s[8:11], s97 offen lds
    s_add_u32 s97, s94, s91
    s_add_u32 m0, s97, s96
    s_nop 0
    buffer_load_dwordx4 v1, s[8:11], s97 offen lds
    s_add_u32 m0, s87, 102400
    s_mul_i32 s96, s59, 163840
    s_add_u32 s96, s96, s95
    buffer_load_dwordx4 v28, s[12:15], s96 offen offset:0 lds
    buffer_load_dwordx4 v29, s[12:15], s96 offen offset:1024 lds
    buffer_load_dwordx4 v30, s[12:15], s96 offen offset:2048 lds
    buffer_load_dwordx4 v31, s[12:15], s96 offen offset:3072 lds
    s_add_u32 m0, s87, 106496
    s_add_u32 s96, s96, 4096
    buffer_load_dwordx4 v32, s[12:15], s96 offen lds
    s_add_u32 s59, s59, 1
    s_cmp_eq_u32 s59, 5
    s_cselect_b32 s59, 0, s59
    v_mov_b32 v1, v19
    s_mov_b32 s92, 81920
    s_mov_b32 s88, 5
    s_waitcnt vmcnt(8) lgkmcnt(0)
L_qloop:
    v_add_u32 v15, s92, v16
    s_barrier
    ds_read_b128 v[136:139], v10
    ds_read_b64_tr_b16 v[116:117], v15 offset:0
    ds_read_b64_tr_b16 v[118:119], v15 offset:1280
    ds_read_b64_tr_b16 v[120:121], v15 offset:8
    ds_read_b64_tr_b16 v[122:123], v15 offset:1288
    ds_read_b64_tr_b16 v[124:125], v15 offset:16
    ds_read_b64_tr_b16 v[126:127], v15 offset:1296
    ds_read_b64_tr_b16 v[128:129], v15 offset:24
    ds_read_b64_tr_b16 v[130:131], v15 offset:1304
    ds_read_b64_tr_b16 v[132:133], v15 offset:32
    ds_read_b64_tr_b16 v[134:135], v15 offset:1312
    s_add_u32 s92, s92, 20480
    s_cmp_eq_u32 s92, 143360
    s_cselect_b32 s92, 81920, s92
    s_add_u32 s57, s57, 1
    s_cmp_eq_u32 s57, 5
    s_cselect_b32 s93, -4, 1
    s_lshl_b32 s93, s93, 12
    s_sub_u32 s88, s88, 1
    s_cmp_eq_u32 s88, 0
    ds_read_b128 v[140:143], v11
    s_waitcnt lgkmcnt(7)
    v_mfma_f32_16x16x32_bf16 v[96:99], v[116:119], v[136:139], v[96:99]
    ds_read_b64_tr_b16 v[116:117], v15 offset:5120
    ds_read_b64_tr_b16 v[118:119], v15 offset:6400
    v_mfma_f32_16x16x32_bf16 v[100:103], v[120:123], v[136:139], v[100:103]
    ds_read_b64_tr_b16 v[120:121], v15 offset:5128
    ds_read_b64_tr_b16 v[122:123], v15 offset:6408
    s_waitcnt lgkmcnt(7)
    v_mfma_f32_16x16x32_bf16 v[104:107], v[124:127], v[136:139], v[104:107]
    ds_read_b64_tr_b16 v[124:125], v15 offset:5136
    ds_read_b64_tr_b16 v[126:127], v15 offset:6416
    v_mfma_f32_16x16x32_bf16 v[108:111], v[128:131], v[136:139], v[108:111]
    ds_read_b64_tr_b16 v[128:129], v15 offset:5144
    ds_read_b64_tr_b16 v[130:131], v15 offset:6424
    s_waitcnt lgkmcnt(9)
    v_mfma_f32_16x16x32_bf16 v[112:115], v[132:135], v[136:139], v[112:115]
    ds_read_b64_tr_b16 v[132:133], v15 offset:5152
    ds_read_b64_tr_b16 v[134:135], v15 offset:6432
    ds_read_b128 v[136:139], v12
    s_waitcnt lgkmcnt(7)
    v_mfma_f32_16x16x32_bf16 v[96:99], v[116:119], v[140:143], v[96:99]
    ds_read_b64_tr_b16 v[116:117], v15 offset:10240
    ds_read_b64_tr_b16 v[118:119], v15 offset:11520
    v_mfma_f32_16x16x32_bf16 v[100:103], v[120:123], v[140:143], v[100:103]
    ds_read_b64_tr_b16 v[120:121], v15 offset:10248
    ds_read_b64_tr_b16 v[122:123], v15 offset:11528
    s_waitcnt lgkmcnt(7)
    v_mfma_f32_16x16x32_bf16 v[104:107], v[124:127], v[140:143], v[104:107]
    ds_read_b64_tr_b16 v[124:125], v15 offset:10256
    ds_read_b64_tr_b16 v[126:127], v15 offset:11536
    v_mfma_f32_16x16x32_bf16 v[108:111], v[128:131], v[140:143], v[108:111]
    ds_read_b64_tr_b16 v[128:129], v15 offset:10264
    ds_read_b64_tr_b16 v[130:131], v15 offset:11544
    s_waitcnt lgkmcnt(9)
    v_mfma_f32_16x16x32_bf16 v[112:115], v[132:135], v[140:143], v[112:115]
    ds_read_b64_tr_b16 v[132:133], v15 offset:10272
    ds_read_b64_tr_b16 v[134:135], v15 offset:11552
    ds_read_b128 v[140:143], v13
    s_waitcnt lgkmcnt(7)
    v_mfma_f32_16x16x32_bf16 v[96:99], v[116:119], v[136:139], v[96:99]
    ds_read_b64_tr_b16 v[116:117], v15 offset:15360
    ds_read_b64_tr_b16 v[118:119], v15 offset:16640
    v_mfma_f32_16x16x32_bf16 v[100:103], v[120:123], v[136:139], v[100:103]
    ds_read_b64_tr_b16 v[120:121], v15 offset:15368
    ds_read_b64_tr_b16 v[122:123], v15 offset:16648
    s_waitcnt lgkmcnt(7)
    v_mfma_f32_16x16x32_bf16 v[104:107], v[124:127], v[136:139], v[104:107]
    ds_read_b64_tr_b16 v[124:125], v15 offset:15376
    ds_read_b64_tr_b16 v[126:127], v15 offset:16656
    v_mfma_f32_16x16x32_bf16 v[108:111], v[128:131], v[136:139], v[108:111]
    ds_read_b64_tr_b16 v[128:129], v15 offset:15384
    ds_read_b64_tr_b16 v[130:131], v15 offset:16664
    s_waitcnt lgkmcnt(9)
    v_mfma_f32_16x16x32_bf16 v[112:115], v[132:135], v[136:139], v[112:115]
    ds_read_b64_tr_b16 v[132:133], v15 offset:15392
    ds_read_b64_tr_b16 v[134:135], v15 offset:16672
    s_waitcnt lgkmcnt(6)
    v_mfma_f32_16x16x32_bf16 v[96:99], v[116:119], v[140:143], v[96:99]
    v_add_u32 v10, s93, v10
    v_mfma_f32_16x16x32_bf16 v[100:103], v[120:123], v[140:143], v[100:103]
    v_add_u32 v11, s93, v11
    s_waitcnt lgkmcnt(2)
    v_mfma_f32_16x16x32_bf16 v[104:107], v[124:127], v[140:143], v[104:107]
    v_add_u32 v12, s93, v12
    v_mfma_f32_16x16x32_bf16 v[108:111], v[128:131], v[140:143], v[108:111]
    v_add_u32 v13, s93, v13
    s_waitcnt lgkmcnt(0)
    v_mfma_f32_16x16x32_bf16 v[112:115], v[132:135], v[140:143], v[112:115]
    s_cbranch_scc1 L_qend
    s_waitcnt vmcnt(0)
    s_branch L_qloop
L_qend:
    s_nop 1
    v_pk_mul_f32 v[96:97], v[96:97], v[26:27] op_sel_hi:[1,0]
    v_cvt_pk_bf16_f32 v116, v96, v97
    v_pk_mul_f32 v[98:99], v[98:99], v[26:27] op_sel_hi:[1,0]
    v_cvt_pk_bf16_f32 v117, v98, v99
    v_pk_mul_f32 v[100:101], v[100:101], v[26:27] op_sel_hi:[1,0]
    v_cvt_pk_bf16_f32 v118, v100, v101
    v_pk_mul_f32 v[102:103], v[102:103], v[26:27] op_sel_hi:[1,0]
    v_cvt_pk_bf16_f32 v119, v102, v103
    ds_write_b128 v17, v[116:119]
    v_pk_mul_f32 v[104:105], v[104:105], v[26:27] op_sel_hi:[1,0]
    v_cvt_pk_bf16_f32 v120, v104, v105
    v_pk_mul_f32 v[106:107], v[106:107], v[26:27] op_sel_hi:[1,0]
    v_cvt_pk_bf16_f32 v121, v106, v107
    v_pk_mul_f32 v[108:109], v[108:109], v[26:27] op_sel_hi:[1,0]
    v_cvt_pk_bf16_f32 v122, v108, v109
    v_pk_mul_f32 v[110:111], v[110:111], v[26:27] op_sel_hi:[1,0]
    v_cvt_pk_bf16_f32 v123, v110, v111
    ds_write_b128 v17, v[120:123] offset:512
    v_pk_mul_f32 v[112:113], v[112:113], v[26:27] op_sel_hi:[1,0]
    v_cvt_pk_bf16_f32 v124, v112, v113
    v_pk_mul_f32 v[114:115], v[114:115], v[26:27] op_sel_hi:[1,0]
    v_cvt_pk_bf16_f32 v125, v114, v115
    ds_write2_b32 v18, v124, v125 offset0:0 offset1:32
    s_mul_i32 s87, s86, 40960
    buffer_load_dwordx4 v[40:43], v2, s[36:39], s87 offen
    buffer_load_dword v56, v3, s[36:39], s87 offen offset:512
    s_mul_i32 s97, s86, 16
    s_bitset1_b32 s97, 0
    s_mul_i32 s97, s97, 2560
    buffer_load_dwordx4 v[44:47], v2, s[36:39], s97 offen
    buffer_load_dword v58, v3, s[36:39], s97 offen offset:512
L_qdone:
    s_waitcnt lgkmcnt(0)
    s_barrier
    ds_read_b128 v[16:19], v236 offset:0
    ds_read_b32 v20, v238 offset:1024
    ds_read_b128 v[22:25], v236 offset:1280
    ds_read_b32 v26, v238 offset:2304
    ds_read_b128 v[28:31], v237 offset:0
    ds_read_b32 v32, v239 offset:1024
    ds_read_b128 v[34:37], v237 offset:1280
    ds_read_b32 v38, v239 offset:2304
    s_cmp_ge_u32 s3, 4
    s_cbranch_scc1 L_bmax
    ds_read_b32 v15, v226 offset:20
    s_mov_b64 exec, s[98:99]
    buffer_load_dwordx4 v[64:67], v4, s[36:39], s87 offen offset:1280
    buffer_load_dwordx4 v[80:83], v4, s[36:39], s87 offen offset:1920
    s_mov_b64 exec, -1
    s_add_u32 s87, s87, 2560
    s_mov_b64 exec, s[98:99]
    buffer_load_dwordx4 v[68:71], v4, s[36:39], s87 offen offset:1280
    buffer_load_dwordx4 v[84:87], v4, s[36:39], s87 offen offset:1920
    s_mov_b64 exec, -1
    s_add_u32 s87, s87, 2560
    buffer_load_dwordx4 v[48:51], v2, s[36:39], s87 offen
    buffer_load_dword v60, v3, s[36:39], s87 offen offset:512
    s_mov_b64 exec, s[98:99]
    buffer_load_dwordx4 v[72:75], v4, s[36:39], s87 offen offset:1280
    buffer_load_dwordx4 v[88:91], v4, s[36:39], s87 offen offset:1920
    s_mov_b64 exec, -1
    s_cmp_eq_u32 s3, 2
    s_waitcnt vmcnt(8) lgkmcnt(0)
    s_cbranch_scc0 L_biasrd
    v_readfirstlane_b32 s93, v15
    s_mov_b32 m0, 145536
    s_mul_i32 s93, s93, 1280
    s_nop 2
    buffer_load_dwordx4 v5, s[8:11], s93 offen lds
    buffer_load_dword v6, s[8:11], s93 offen offset:1024 lds
    s_branch L_biasrd
L_bmax:
    s_waitcnt vmcnt(6) lgkmcnt(6)
    v_mfma_f32_32x32x16_bf16 v[112:127], v[40:43], v[16:19], 0
    v_mfma_f32_32x32x8_bf16 v[112:127], v[56:57], v[20:21], v[112:127]
    v_mfma_f32_32x32x16_bf16 v[128:143], v[44:47], v[16:19], 0
    v_mfma_f32_32x32x8_bf16 v[128:143], v[58:59], v[20:21], v[128:143]
    s_waitcnt lgkmcnt(4)
    s_getreg_b32 s92, hwreg(HW_REG_XCC_ID, 0, 4)
    s_or_b32 s92, s92, s84
    v_cmp_eq_u32 vcc, s92, v15
    s_nop 0
    s_cmp_eq_u64 vcc, -1
    s_cselect_b32 s15, 1, 0
    s_cselect_b64 s[32:33], s[44:45], s[32:33]
    v_mov_b32 v12, s15
    ds_write_b32 v226, v12 offset:24
    v_mfma_f32_32x32x16_bf16 v[96:111], v[40:43], v[22:25], 0
    v_max3_f32 v10, v112, v113, v113
    v_max3_f32 v10, v114, v115, v10
    v_max3_f32 v10, v116, v117, v10
    v_max3_f32 v10, v118, v119, v10
    v_max3_f32 v10, v120, v121, v10
    v_max3_f32 v10, v122, v123, v10
    v_max3_f32 v10, v124, v125, v10
    v_max3_f32 v10, v126, v127, v10
    v_mfma_f32_32x32x8_bf16 v[96:111], v[56:57], v[26:27], v[96:111]
    v_mfma_f32_32x32x16_bf16 v[112:127], v[44:47], v[22:25], 0
    v_max3_f32 v10, v128, v129, v10
    v_max3_f32 v10, v130, v131, v10
    v_max3_f32 v10, v132, v133, v10
    v_max3_f32 v10, v134, v135, v10
    v_max3_f32 v10, v136, v137, v10
    v_max3_f32 v10, v138, v139, v10
    v_max3_f32 v10, v140, v141, v10
    v_max3_f32 v10, v142, v143, v10
    v_mfma_f32_32x32x8_bf16 v[112:127], v[58:59], v[26:27], v[112:127]
    s_nop 1
    v_max3_f32 v11, v96, v97, v97
    v_max3_f32 v11, v98, v99, v11
    v_max3_f32 v11, v100, v101, v11
    v_max3_f32 v11, v102, v103, v11
    v_max3_f32 v11, v104, v105, v11
    v_max3_f32 v11, v106, v107, v11
    v_max3_f32 v11, v108, v109, v11
    v_max3_f32 v11, v110, v111, v11
    s_nop 1
    v_max3_f32 v11, v112, v113, v11
    v_max3_f32 v11, v114, v115, v11
    v_max3_f32 v11, v116, v117, v11
    v_max3_f32 v11, v118, v119, v11
    v_max3_f32 v11, v120, v121, v11
    v_max3_f32 v11, v122, v123, v11
    v_max3_f32 v11, v124, v125, v11
    v_max3_f32 v11, v126, v127, v11
    s_nop 1
    v_permlane32_swap_b32 v10, v11
    v_max_f32 v10, v10, v11
    v_sub_f32 v10, 0xc2c80000, v10
    v_cvt_pk_bf16_f32 v10, v10, 0
    ds_write_b32 v240, v10
L_biasrd:
    s_mov_b32 s88, 8
    s_cmp_eq_u32 s3, 3
    s_cselect_b32 s57, 4, 5
    s_cmp_lg_u32 s24, 0
    s_cselect_b64 vcc, -1, 0
    s_cmp_ge_u32 s3, 4
    s_setprio 3
    s_cbranch_scc0 L_pb
    s_setprio 2
L_pb:
    s_waitcnt lgkmcnt(1)
    v_mfma_f32_32x32x16_bf16 v[96:111], v[40:43], v[16:19], 0
    s_waitcnt lgkmcnt(0)
    s_barrier
    ds_read_b32 v21, v241 offset:0
    ds_read_b32 v27, v241 offset:128
    ds_read_b32 v33, v242 offset:0
    ds_read_b32 v39, v242 offset:128
    s_waitcnt lgkmcnt(3)
    v_mfma_f32_32x32x8_bf16 v[96:111], v[56:57], v[20:21], v[96:111]
    s_lshl3_add_u32 s92, s90, s3
    s_sub_u32 s93, s92, 4
    s_cmp_lt_u32 s93, 4
    s_cbranch_scc0 L_bin
    s_mov_b64 exec, s[98:99]
    buffer_load_dwordx4 v[72:75], v4, s[36:39], s87 offen offset:1280
    buffer_load_dwordx4 v[88:91], v4, s[36:39], s87 offen offset:1920
    s_mov_b64 exec, -1
L_bin:
    s_add_u32 s87, s87, 2560
    buffer_load_dwordx4 v[52:55], v2, s[36:39], s87 offen
    buffer_load_dword v62, v3, s[36:39], s87 offen offset:512
    s_waitcnt vmcnt(8) lgkmcnt(0)
    s_mov_b32 m0, s26
    s_nop 1
    .p2align 3
L_loop:
    v_mfma_f32_32x32x8_bf16 v[112:127], v[56:57], v[26:27], 0
    v_exp_f32 v96, v96
    v_exp_f32 v97, v97
    v_exp_f32 v98, v98
    v_exp_f32 v99, v99
    v_mfma_f32_32x32x16_bf16 v[112:127], v[40:43], v[22:25], v[112:127]
    v_exp_f32 v100, v100
    v_exp_f32 v101, v101
    v_exp_f32 v102, v102
    v_exp_f32 v103, v103
    v_smfmac_f32_32x32x32_bf16 v[208:223], v[92:95], v[152:159], v14
    v_exp_f32 v104, v104
    v_exp_f32 v105, v105
    v_exp_f32 v106, v106
    v_exp_f32 v107, v107
    v_smfmac_f32_32x32x32_bf16 v[160:175], v[64:67], v[96:103], v14
    v_exp_f32 v108, v108
    v_exp_f32 v109, v109
    v_exp_f32 v110, v110
    v_exp_f32 v111, v111
    s_mov_b64 exec, s[98:99]
    buffer_load_dwordx4 v[76:79], v4, s[36:39], s87 offen offset:1280
    buffer_load_dwordx4 v[92:95], v4, s[36:39], s87 offen offset:1920
    s_mov_b64 exec, -1
    v_mfma_f32_32x32x8_bf16 v[128:143], v[56:57], v[32:33], 0
    v_exp_f32 v112, v112
    v_exp_f32 v113, v113
    v_exp_f32 v114, v114
    v_exp_f32 v115, v115
    v_mfma_f32_32x32x16_bf16 v[128:143], v[40:43], v[28:31], v[128:143]
    v_exp_f32 v116, v116
    v_exp_f32 v117, v117
    v_exp_f32 v118, v118
    v_exp_f32 v119, v119
    s_cbranch_vccz L_nojob_10
    buffer_load_dwordx4 v224, s[16:19], s25 offen lds
    s_add_u32 m0, m0, s28
    s_add_u32 s25, s25, s27
    buffer_load_dwordx4 v224, s[16:19], s25 offen lds
    s_add_u32 m0, m0, s28
    s_sub_u32 s24, s24, 2
    s_cmp_eq_u32 s24, s29
    s_cselect_b32 s92, s30, s27
    s_add_u32 s25, s25, s92
    s_cmp_lg_u32 s24, 0
    s_cselect_b64 vcc, -1, 0
L_nojob_10:
    v_smfmac_f32_32x32x32_bf16 v[160:175], v[80:83], v[104:111], v14
    v_exp_f32 v120, v120
    v_exp_f32 v121, v121
    v_exp_f32 v122, v122
    v_exp_f32 v123, v123
    v_smfmac_f32_32x32x32_bf16 v[176:191], v[64:67], v[112:119], v14
    v_exp_f32 v124, v124
    v_exp_f32 v125, v125
    v_exp_f32 v126, v126
    v_exp_f32 v127, v127
    v_mfma_f32_32x32x8_bf16 v[144:159], v[56:57], v[38:39], 0
    v_exp_f32 v128, v128
    v_exp_f32 v129, v129
    v_exp_f32 v130, v130
    v_exp_f32 v131, v131
    v_mfma_f32_32x32x16_bf16 v[144:159], v[40:43], v[34:37], v[144:159]
    v_exp_f32 v132, v132
    v_exp_f32 v133, v133
    v_exp_f32 v134, v134
    v_exp_f32 v135, v135
    s_add_u32 s87, s87, 2560
    buffer_load_dwordx4 v[40:43], v2, s[36:39], s87 offen
    buffer_load_dword v56, v3, s[36:39], s87 offen offset:512
    v_smfmac_f32_32x32x32_bf16 v[176:191], v[80:83], v[120:127], v14
    v_exp_f32 v136, v136
    v_exp_f32 v137, v137
    v_exp_f32 v138, v138
    v_exp_f32 v139, v139
    v_smfmac_f32_32x32x32_bf16 v[192:207], v[64:67], v[128:135], v14
    v_exp_f32 v140, v140
    v_exp_f32 v141, v141
    v_exp_f32 v142, v142
    v_exp_f32_e64 v143, v143
    s_waitcnt vmcnt(10)
    v_mfma_f32_32x32x8_bf16 v[96:111], v[58:59], v[20:21], 0
    v_exp_f32 v144, v144
    v_exp_f32 v145, v145
    v_exp_f32 v146, v146
    v_exp_f32 v147, v147
    v_mfma_f32_32x32x16_bf16 v[96:111], v[44:47], v[16:19], v[96:111]
    v_exp_f32 v148, v148
    v_exp_f32 v149, v149
    v_exp_f32 v150, v150
    v_exp_f32 v151, v151
    v_smfmac_f32_32x32x32_bf16 v[192:207], v[80:83], v[136:143], v14
    v_exp_f32 v152, v152
    v_exp_f32 v153, v153
    v_exp_f32 v154, v154
    v_exp_f32 v155, v155
    v_smfmac_f32_32x32x32_bf16 v[208:223], v[64:67], v[144:151], v14
    v_exp_f32 v156, v156
    v_exp_f32 v157, v157
    v_exp_f32 v158, v158
    v_exp_f32 v159, v159
    v_mfma_f32_32x32x8_bf16 v[112:127], v[58:59], v[26:27], 0
    v_exp_f32 v96, v96
    v_exp_f32 v97, v97
    v_exp_f32 v98, v98
    v_exp_f32 v99, v99
    v_mfma_f32_32x32x16_bf16 v[112:127], v[44:47], v[22:25], v[112:127]
    v_exp_f32 v100, v100
    v_exp_f32 v101, v101
    v_exp_f32 v102, v102
    v_exp_f32 v103, v103
    v_smfmac_f32_32x32x32_bf16 v[208:223], v[80:83], v[152:159], v14
    v_exp_f32 v104, v104
    v_exp_f32 v105, v105
    v_exp_f32 v106, v106
    v_exp_f32 v107, v107
    v_smfmac_f32_32x32x32_bf16 v[160:175], v[68:71], v[96:103], v14
    v_exp_f32 v108, v108
    v_exp_f32 v109, v109
    v_exp_f32 v110, v110
    v_exp_f32 v111, v111
    s_mov_b64 exec, s[98:99]
    buffer_load_dwordx4 v[64:67], v4, s[36:39], s87 offen offset:1280
    buffer_load_dwordx4 v[80:83], v4, s[36:39], s87 offen offset:1920
    s_mov_b64 exec, -1
    v_mfma_f32_32x32x8_bf16 v[128:143], v[58:59], v[32:33], 0
    v_exp_f32 v112, v112
    v_exp_f32 v113, v113
    v_exp_f32 v114, v114
    v_exp_f32 v115, v115
    v_mfma_f32_32x32x16_bf16 v[128:143], v[44:47], v[28:31], v[128:143]
    v_exp_f32 v116, v116
    v_exp_f32 v117, v117
    v_exp_f32 v118, v118
    v_exp_f32 v119, v119
    s_cbranch_vccz L_nojob_11
    buffer_load_dwordx4 v224, s[16:19], s25 offen lds
    s_add_u32 m0, m0, s28
    s_add_u32 s25, s25, s27
    buffer_load_dwordx4 v224, s[16:19], s25 offen lds
    s_add_u32 m0, m0, s28
    s_sub_u32 s24, s24, 2
    s_cmp_eq_u32 s24, s29
    s_cselect_b32 s92, s30, s27
    s_add_u32 s25, s25, s92
    s_cmp_lg_u32 s24, 0
    s_cselect_b64 vcc, -1, 0
L_nojob_11:
    v_smfmac_f32_32x32x32_bf16 v[160:175], v[84:87], v[104:111], v14
    v_exp_f32 v120, v120
    v_exp_f32 v121, v121
    v_exp_f32 v122, v122
    v_exp_f32 v123, v123
    v_smfmac_f32_32x32x32_bf16 v[176:191], v[68:71], v[112:119], v14
    v_exp_f32 v124, v124
    v_exp_f32 v125, v125
    v_exp_f32 v126, v126
    v_exp_f32 v127, v127
    v_mfma_f32_32x32x8_bf16 v[144:159], v[58:59], v[38:39], 0
    v_exp_f32 v128, v128
    v_exp_f32 v129, v129
    v_exp_f32 v130, v130
    v_exp_f32 v131, v131
    v_mfma_f32_32x32x16_bf16 v[144:159], v[44:47], v[34:37], v[144:159]
    v_exp_f32 v132, v132
    v_exp_f32 v133, v133
    v_exp_f32 v134, v134
    v_exp_f32 v135, v135
    s_add_u32 s87, s87, 2560
    buffer_load_dwordx4 v[44:47], v2, s[36:39], s87 offen
    buffer_load_dword v58, v3, s[36:39], s87 offen offset:512
    v_smfmac_f32_32x32x32_bf16 v[176:191], v[84:87], v[120:127], v14
    v_exp_f32 v136, v136
    v_exp_f32 v137, v137
    v_exp_f32 v138, v138
    v_exp_f32 v139, v139
    v_smfmac_f32_32x32x32_bf16 v[192:207], v[68:71], v[128:135], v14
    v_exp_f32 v140, v140
    v_exp_f32 v141, v141
    v_exp_f32 v142, v142
    v_exp_f32_e64 v143, v143
    s_waitcnt vmcnt(10)
    v_mfma_f32_32x32x8_bf16 v[96:111], v[60:61], v[20:21], 0
    v_exp_f32 v144, v144
    v_exp_f32 v145, v145
    v_exp_f32 v146, v146
    v_exp_f32 v147, v147
    v_mfma_f32_32x32x16_bf16 v[96:111], v[48:51], v[16:19], v[96:111]
    v_exp_f32 v148, v148
    v_exp_f32 v149, v149
    v_exp_f32 v150, v150
    v_exp_f32 v151, v151
    v_smfmac_f32_32x32x32_bf16 v[192:207], v[84:87], v[136:143], v14
    v_exp_f32 v152, v152
    v_exp_f32 v153, v153
    v_exp_f32 v154, v154
    v_exp_f32 v155, v155
    v_smfmac_f32_32x32x32_bf16 v[208:223], v[68:71], v[144:151], v14
    v_exp_f32 v156, v156
    v_exp_f32 v157, v157
    v_exp_f32 v158, v158
    v_exp_f32_e64 v159, v159
    s_sub_u32 s88, s88, 1
    s_cmp_eq_u32 s88, s57
    s_cbranch_scc1 L_hook
L_mid:
    v_mfma_f32_32x32x8_bf16 v[112:127], v[60:61], v[26:27], 0
    v_exp_f32 v96, v96
    v_exp_f32 v97, v97
    v_exp_f32 v98, v98
    v_exp_f32 v99, v99
    v_mfma_f32_32x32x16_bf16 v[112:127], v[48:51], v[22:25], v[112:127]
    v_exp_f32 v100, v100
    v_exp_f32 v101, v101
    v_exp_f32 v102, v102
    v_exp_f32 v103, v103
    v_smfmac_f32_32x32x32_bf16 v[208:223], v[84:87], v[152:159], v14
    v_exp_f32 v104, v104
    v_exp_f32 v105, v105
    v_exp_f32 v106, v106
    v_exp_f32 v107, v107
    v_smfmac_f32_32x32x32_bf16 v[160:175], v[72:75], v[96:103], v14
    v_exp_f32 v108, v108
    v_exp_f32 v109, v109
    v_exp_f32 v110, v110
    v_exp_f32 v111, v111
    s_mov_b64 exec, s[98:99]
    buffer_load_dwordx4 v[68:71], v4, s[36:39], s87 offen offset:1280
    buffer_load_dwordx4 v[84:87], v4, s[36:39], s87 offen offset:1920
    s_mov_b64 exec, -1
    v_mfma_f32_32x32x8_bf16 v[128:143], v[60:61], v[32:33], 0
    v_exp_f32 v112, v112
    v_exp_f32 v113, v113
    v_exp_f32 v114, v114
    v_exp_f32 v115, v115
    v_mfma_f32_32x32x16_bf16 v[128:143], v[48:51], v[28:31], v[128:143]
    v_exp_f32 v116, v116
    v_exp_f32 v117, v117
    v_exp_f32 v118, v118
    v_exp_f32 v119, v119
    s_cbranch_vccz L_nojob_12
    buffer_load_dwordx4 v224, s[16:19], s25 offen lds
    s_add_u32 m0, m0, s28
    s_add_u32 s25, s25, s27
    buffer_load_dwordx4 v224, s[16:19], s25 offen lds
    s_add_u32 m0, m0, s28
    s_sub_u32 s24, s24, 2
    s_cmp_eq_u32 s24, s29
    s_cselect_b32 s92, s30, s27
    s_add_u32 s25, s25, s92
    s_cmp_lg_u32 s24, 0
    s_cselect_b64 vcc, -1, 0
L_nojob_12:
    v_smfmac_f32_32x32x32_bf16 v[160:175], v[88:91], v[104:111], v14
    v_exp_f32 v120, v120
    v_exp_f32 v121, v121
    v_exp_f32 v122, v122
    v_exp_f32 v123, v123
    v_smfmac_f32_32x32x32_bf16 v[176:191], v[72:75], v[112:119], v14
    v_exp_f32 v124, v124
    v_exp_f32 v125, v125
    v_exp_f32 v126, v126
    v_exp_f32 v127, v127
    v_mfma_f32_32x32x8_bf16 v[144:159], v[60:61], v[38:39], 0
    v_exp_f32 v128, v128
    v_exp_f32 v129, v129
    v_exp_f32 v130, v130
    v_exp_f32 v131, v131
    v_mfma_f32_32x32x16_bf16 v[144:159], v[48:51], v[34:37], v[144:159]
    v_exp_f32 v132, v132
    v_exp_f32 v133, v133
    v_exp_f32 v134, v134
    v_exp_f32 v135, v135
    s_add_u32 s87, s87, 2560
    buffer_load_dwordx4 v[48:51], v2, s[36:39], s87 offen
    buffer_load_dword v60, v3, s[36:39], s87 offen offset:512
    v_smfmac_f32_32x32x32_bf16 v[176:191], v[88:91], v[120:127], v14
    v_exp_f32 v136, v136
    v_exp_f32 v137, v137
    v_exp_f32 v138, v138
    v_exp_f32 v139, v139
    v_smfmac_f32_32x32x32_bf16 v[192:207], v[72:75], v[128:135], v14
    v_exp_f32 v140, v140
    v_exp_f32 v141, v141
    v_exp_f32 v142, v142
    v_exp_f32_e64 v143, v143
    s_waitcnt vmcnt(10)
    v_mfma_f32_32x32x8_bf16 v[96:111], v[62:63], v[20:21], 0
    v_exp_f32 v144, v144
    v_exp_f32 v145, v145
    v_exp_f32 v146, v146
    v_exp_f32 v147, v147
    v_mfma_f32_32x32x16_bf16 v[96:111], v[52:55], v[16:19], v[96:111]
    v_exp_f32 v148, v148
    v_exp_f32 v149, v149
    v_exp_f32 v150, v150
    v_exp_f32 v151, v151
    v_smfmac_f32_32x32x32_bf16 v[192:207], v[88:91], v[136:143], v14
    v_exp_f32 v152, v152
    v_exp_f32 v153, v153
    v_exp_f32 v154, v154
    v_exp_f32 v155, v155
    v_smfmac_f32_32x32x32_bf16 v[208:223], v[72:75], v[144:151], v14
    v_exp_f32 v156, v156
    v_exp_f32 v157, v157
    v_exp_f32 v158, v158
    v_exp_f32 v159, v159
    v_mfma_f32_32x32x8_bf16 v[112:127], v[62:63], v[26:27], 0
    v_exp_f32 v96, v96
    v_exp_f32 v97, v97
    v_exp_f32 v98, v98
    v_exp_f32 v99, v99
    v_mfma_f32_32x32x16_bf16 v[112:127], v[52:55], v[22:25], v[112:127]
    v_exp_f32 v100, v100
    v_exp_f32 v101, v101
    v_exp_f32 v102, v102
    v_exp_f32 v103, v103
    v_smfmac_f32_32x32x32_bf16 v[208:223], v[88:91], v[152:159], v14
    v_exp_f32 v104, v104
    v_exp_f32 v105, v105
    v_exp_f32 v106, v106
    v_exp_f32 v107, v107
    v_smfmac_f32_32x32x32_bf16 v[160:175], v[76:79], v[96:103], v14
    v_exp_f32 v108, v108
    v_exp_f32 v109, v109
    v_exp_f32 v110, v110
    v_exp_f32 v111, v111
    s_mov_b64 exec, s[98:99]
    buffer_load_dwordx4 v[72:75], v4, s[36:39], s87 offen offset:1280
    buffer_load_dwordx4 v[88:91], v4, s[36:39], s87 offen offset:1920
    s_mov_b64 exec, -1
    v_mfma_f32_32x32x8_bf16 v[128:143], v[62:63], v[32:33], 0
    v_exp_f32 v112, v112
    v_exp_f32 v113, v113
    v_exp_f32 v114, v114
    v_exp_f32 v115, v115
    v_mfma_f32_32x32x16_bf16 v[128:143], v[52:55], v[28:31], v[128:143]
    v_exp_f32 v116, v116
    v_exp_f32 v117, v117
    v_exp_f32 v118, v118
    v_exp_f32 v119, v119
    s_cbranch_vccz L_nojob_13
    buffer_load_dwordx4 v224, s[16:19], s25 offen lds
    s_add_u32 m0, m0, s28
    s_add_u32 s25, s25, s27
    buffer_load_dwordx4 v224, s[16:19], s25 offen lds
    s_add_u32 m0, m0, s28
    s_sub_u32 s24, s24, 2
    s_cmp_eq_u32 s24, s29
    s_cselect_b32 s92, s30, s27
    s_add_u32 s25, s25, s92
    s_cmp_lg_u32 s24, 0
    s_cselect_b64 vcc, -1, 0
L_nojob_13:
    v_smfmac_f32_32x32x32_bf16 v[160:175], v[92:95], v[104:111], v14
    v_exp_f32 v120, v120
    v_exp_f32 v121, v121
    v_exp_f32 v122, v122
    v_exp_f32 v123, v123
    v_smfmac_f32_32x32x32_bf16 v[176:191], v[76:79], v[112:119], v14
    v_exp_f32 v124, v124
    v_exp_f32 v125, v125
    v_exp_f32 v126, v126
    v_exp_f32 v127, v127
    v_mfma_f32_32x32x8_bf16 v[144:159], v[62:63], v[38:39], 0
    v_exp_f32 v128, v128
    v_exp_f32 v129, v129
    v_exp_f32 v130, v130
    v_exp_f32 v131, v131
    v_mfma_f32_32x32x16_bf16 v[144:159], v[52:55], v[34:37], v[144:159]
    v_exp_f32 v132, v132
    v_exp_f32 v133, v133
    v_exp_f32 v134, v134
    v_exp_f32 v135, v135
    s_add_u32 s87, s87, 2560
    buffer_load_dwordx4 v[52:55], v2, s[36:39], s87 offen
    buffer_load_dword v62, v3, s[36:39], s87 offen offset:512
    v_smfmac_f32_32x32x32_bf16 v[176:191], v[92:95], v[120:127], v14
    v_exp_f32 v136, v136
    v_exp_f32 v137, v137
    v_exp_f32 v138, v138
    v_exp_f32 v139, v139
    v_smfmac_f32_32x32x32_bf16 v[192:207], v[76:79], v[128:135], v14
    v_exp_f32 v140, v140
    v_exp_f32 v141, v141
    v_exp_f32 v142, v142
    v_exp_f32_e64 v143, v143
    s_waitcnt vmcnt(10)
    v_mfma_f32_32x32x8_bf16 v[96:111], v[56:57], v[20:21], 0
    v_exp_f32 v144, v144
    v_exp_f32 v145, v145
    v_exp_f32 v146, v146
    v_exp_f32 v147, v147
    v_mfma_f32_32x32x16_bf16 v[96:111], v[40:43], v[16:19], v[96:111]
    v_exp_f32 v148, v148
    v_exp_f32 v149, v149
    v_exp_f32 v150, v150
    v_exp_f32 v151, v151
    v_smfmac_f32_32x32x32_bf16 v[192:207], v[92:95], v[136:143], v14
    v_exp_f32 v152, v152
    v_exp_f32 v153, v153
    v_exp_f32 v154, v154
    v_exp_f32 v155, v155
    v_smfmac_f32_32x32x32_bf16 v[208:223], v[76:79], v[144:151], v14
    v_exp_f32 v156, v156
    v_exp_f32 v157, v157
    v_exp_f32 v158, v158
    v_exp_f32 v159, v159
    s_sub_u32 s88, s88, 1
    s_cmp_eq_u32 s88, s57
    s_cbranch_scc1 L_hook
    s_cmp_lg_u32 s88, 2
    s_cbranch_scc1 L_loop
L_last:
    s_lshl2_add_u32 s92, s3, 161312
    s_xor_b32 s93, s92, 4
    v_mov_b32 v224, s92
    v_mov_b32 v225, s93
    v_mfma_f32_32x32x8_bf16 v[112:127], v[56:57], v[26:27], 0
    v_exp_f32 v96, v96
    v_exp_f32 v97, v97
    v_exp_f32 v98, v98
    v_exp_f32 v99, v99
    v_mfma_f32_32x32x16_bf16 v[112:127], v[40:43], v[22:25], v[112:127]
    v_exp_f32 v100, v100
    v_exp_f32 v101, v101
    v_exp_f32 v102, v102
    v_exp_f32 v103, v103
    v_smfmac_f32_32x32x32_bf16 v[208:223], v[92:95], v[152:159], v14
    v_exp_f32 v104, v104
    v_exp_f32 v105, v105
    v_exp_f32 v106, v106
    v_exp_f32 v107, v107
    v_smfmac_f32_32x32x32_bf16 v[160:175], v[64:67], v[96:103], v14
    v_exp_f32 v108, v108
    v_exp_f32 v109, v109
    v_exp_f32 v110, v110
    v_exp_f32 v111, v111
    s_mov_b64 exec, s[98:99]
    buffer_load_dwordx4 v[76:79], v4, s[36:39], s87 offen offset:1280
    buffer_load_dwordx4 v[92:95], v4, s[36:39], s87 offen offset:1920
    s_mov_b64 exec, -1
    v_mfma_f32_32x32x8_bf16 v[128:143], v[56:57], v[32:33], 0
    v_exp_f32 v112, v112
    v_exp_f32 v113, v113
    v_exp_f32 v114, v114
    v_exp_f32 v115, v115
    v_mfma_f32_32x32x16_bf16 v[128:143], v[40:43], v[28:31], v[128:143]
    v_exp_f32 v116, v116
    v_exp_f32 v117, v117
    v_exp_f32 v118, v118
    v_exp_f32 v119, v119
    v_smfmac_f32_32x32x32_bf16 v[160:175], v[80:83], v[104:111], v14
    v_exp_f32 v120, v120
    v_exp_f32 v121, v121
    v_exp_f32 v122, v122
    v_exp_f32 v123, v123
    v_smfmac_f32_32x32x32_bf16 v[176:191], v[64:67], v[112:119], v14
    v_exp_f32 v124, v124
    v_exp_f32 v125, v125
    v_exp_f32 v126, v126
    v_exp_f32 v127, v127
    v_mfma_f32_32x32x8_bf16 v[144:159], v[56:57], v[38:39], 0
    v_exp_f32 v128, v128
    v_exp_f32 v129, v129
    v_exp_f32 v130, v130
    v_exp_f32 v131, v131
    v_mfma_f32_32x32x16_bf16 v[144:159], v[40:43], v[34:37], v[144:159]
    v_exp_f32 v132, v132
    v_exp_f32 v133, v133
    v_exp_f32 v134, v134
    v_exp_f32 v135, v135
    v_smfmac_f32_32x32x32_bf16 v[176:191], v[80:83], v[120:127], v14
    v_exp_f32 v136, v136
    v_exp_f32 v137, v137
    v_exp_f32 v138, v138
    v_exp_f32 v139, v139
    v_smfmac_f32_32x32x32_bf16 v[192:207], v[64:67], v[128:135], v14
    v_exp_f32 v140, v140
    v_exp_f32 v141, v141
    v_exp_f32 v142, v142
    v_exp_f32_e64 v143, v143
    s_waitcnt vmcnt(8)
    v_mfma_f32_32x32x8_bf16 v[96:111], v[58:59], v[20:21], 0
    v_exp_f32 v144, v144
    v_exp_f32 v145, v145
    v_exp_f32 v146, v146
    v_exp_f32 v147, v147
    v_mfma_f32_32x32x16_bf16 v[96:111], v[44:47], v[16:19], v[96:111]
    v_exp_f32 v148, v148
    v_exp_f32 v149, v149
    v_exp_f32 v150, v150
    v_exp_f32 v151, v151
    v_smfmac_f32_32x32x32_bf16 v[192:207], v[80:83], v[136:143], v14
    v_exp_f32 v152, v152
    v_exp_f32 v153, v153
    v_exp_f32 v154, v154
    v_exp_f32 v155, v155
    v_smfmac_f32_32x32x32_bf16 v[208:223], v[64:67], v[144:151], v14
    v_exp_f32 v156, v156
    v_exp_f32 v157, v157
    v_exp_f32 v158, v158
    v_exp_f32 v159, v159
    v_mfma_f32_32x32x8_bf16 v[112:127], v[58:59], v[26:27], 0
    v_exp_f32 v96, v96
    v_exp_f32 v97, v97
    v_exp_f32 v98, v98
    v_exp_f32 v99, v99
    v_mfma_f32_32x32x16_bf16 v[112:127], v[44:47], v[22:25], v[112:127]
    v_exp_f32 v100, v100
    v_exp_f32 v101, v101
    v_exp_f32 v102, v102
    v_exp_f32 v103, v103
    v_smfmac_f32_32x32x32_bf16 v[208:223], v[80:83], v[152:159], v14
    v_exp_f32 v104, v104
    v_exp_f32 v105, v105
    v_exp_f32 v106, v106
    v_exp_f32 v107, v107
    v_smfmac_f32_32x32x32_bf16 v[160:175], v[68:71], v[96:103], v14
    v_exp_f32 v108, v108
    v_exp_f32 v109, v109
    v_exp_f32 v110, v110
    v_exp_f32 v111, v111
    v_mfma_f32_32x32x8_bf16 v[128:143], v[58:59], v[32:33], 0
    v_exp_f32 v112, v112
    v_exp_f32 v113, v113
    v_exp_f32 v114, v114
    v_exp_f32 v115, v115
    v_mfma_f32_32x32x16_bf16 v[128:143], v[44:47], v[28:31], v[128:143]
    v_exp_f32 v116, v116
    v_exp_f32 v117, v117
    v_exp_f32 v118, v118
    v_exp_f32 v119, v119
    v_smfmac_f32_32x32x32_bf16 v[160:175], v[84:87], v[104:111], v14
    v_exp_f32 v120, v120
    v_exp_f32 v121, v121
    v_exp_f32 v122, v122
    v_exp_f32 v123, v123
    v_smfmac_f32_32x32x32_bf16 v[176:191], v[68:71], v[112:119], v14
    v_exp_f32 v124, v124
    v_exp_f32 v125, v125
    v_exp_f32 v126, v126
    v_exp_f32 v127, v127
    v_mfma_f32_32x32x8_bf16 v[144:159], v[58:59], v[38:39], 0
    v_exp_f32 v128, v128
    v_exp_f32 v129, v129
    v_exp_f32 v130, v130
    v_exp_f32 v131, v131
    v_mfma_f32_32x32x16_bf16 v[144:159], v[44:47], v[34:37], v[144:159]
    v_exp_f32 v132, v132
    v_exp_f32 v133, v133
    v_exp_f32 v134, v134
    v_exp_f32 v135, v135
    v_smfmac_f32_32x32x32_bf16 v[176:191], v[84:87], v[120:127], v14
    v_exp_f32 v136, v136
    v_exp_f32 v137, v137
    v_exp_f32 v138, v138
    v_exp_f32 v139, v139
    v_smfmac_f32_32x32x32_bf16 v[192:207], v[68:71], v[128:135], v14
    v_exp_f32 v140, v140
    v_exp_f32 v141, v141
    v_exp_f32 v142, v142
    v_exp_f32_e64 v143, v143
    s_waitcnt vmcnt(0)
    v_mfma_f32_32x32x8_bf16 v[96:111], v[60:61], v[20:21], 0
    v_exp_f32 v144, v144
    v_exp_f32 v145, v145
    v_exp_f32 v146, v146
    v_exp_f32 v147, v147
    v_mfma_f32_32x32x16_bf16 v[96:111], v[48:51], v[16:19], v[96:111]
    v_exp_f32 v148, v148
    v_exp_f32 v149, v149
    v_exp_f32 v150, v150
    v_exp_f32 v151, v151
    v_smfmac_f32_32x32x32_bf16 v[192:207], v[84:87], v[136:143], v14
    v_exp_f32 v152, v152
    v_exp_f32 v153, v153
    v_exp_f32 v154, v154
    v_exp_f32 v155, v155
    v_smfmac_f32_32x32x32_bf16 v[208:223], v[68:71], v[144:151], v14
    v_exp_f32 v156, v156
    v_exp_f32 v157, v157
    v_exp_f32 v158, v158
    v_exp_f32_e64 v159, v159
    s_cmp_ge_u32 s3, 4
    s_cbranch_scc0 L_nodrop_14
    s_setprio 0
L_nodrop_14:
    v_mfma_f32_32x32x8_bf16 v[112:127], v[60:61], v[26:27], 0
    v_exp_f32 v96, v96
    v_exp_f32 v97, v97
    v_exp_f32 v98, v98
    v_exp_f32 v99, v99
    v_mfma_f32_32x32x16_bf16 v[112:127], v[48:51], v[22:25], v[112:127]
    v_exp_f32 v100, v100
    v_exp_f32 v101, v101
    v_exp_f32 v102, v102
    v_exp_f32 v103, v103
    v_smfmac_f32_32x32x32_bf16 v[208:223], v[84:87], v[152:159], v14
    v_exp_f32 v104, v104
    v_exp_f32 v105, v105
    v_exp_f32 v106, v106
    v_exp_f32 v107, v107
    v_smfmac_f32_32x32x32_bf16 v[160:175], v[72:75], v[96:103], v14
    ds_read_b32 v15, v226 offset:12
    v_exp_f32 v108, v108
    v_exp_f32 v109, v109
    v_exp_f32 v110, v110
    v_exp_f32 v111, v111
    v_mfma_f32_32x32x8_bf16 v[128:143], v[60:61], v[32:33], 0
    v_exp_f32 v112, v112
    v_exp_f32 v113, v113
    v_exp_f32 v114, v114
    v_exp_f32 v115, v115
    v_mfma_f32_32x32x16_bf16 v[128:143], v[48:51], v[28:31], v[128:143]
    v_exp_f32 v116, v116
    v_exp_f32 v117, v117
    v_exp_f32 v118, v118
    v_exp_f32 v119, v119
    v_smfmac_f32_32x32x32_bf16 v[160:175], v[88:91], v[104:111], v14
    v_exp_f32 v120, v120
    v_exp_f32 v121, v121
    v_exp_f32 v122, v122
    v_exp_f32 v123, v123
    v_smfmac_f32_32x32x32_bf16 v[176:191], v[72:75], v[112:119], v14
    v_exp_f32 v124, v124
    v_exp_f32 v125, v125
    v_exp_f32 v126, v126
    v_exp_f32_e64 v127, v127
    s_waitcnt lgkmcnt(0)
    v_readfirstlane_b32 s97, v15
    s_nop 0
    s_cmp_lt_u32 s97, 8
    s_cbranch_scc1 L_mwait
L_mfree:
    v_mfma_f32_32x32x8_bf16 v[144:159], v[60:61], v[38:39], 0
    v_exp_f32 v128, v128
    v_exp_f32 v129, v129
    v_exp_f32 v130, v130
    v_exp_f32 v131, v131
    v_mfma_f32_32x32x16_bf16 v[144:159], v[48:51], v[34:37], v[144:159]
    v_exp_f32 v132, v132
    v_exp_f32 v133, v133
    v_exp_f32 v134, v134
    v_exp_f32 v135, v135
    v_smfmac_f32_32x32x32_bf16 v[176:191], v[88:91], v[120:127], v14
    v_exp_f32 v136, v136
    v_exp_f32 v137, v137
    v_exp_f32 v138, v138
    v_exp_f32 v139, v139
    v_smfmac_f32_32x32x32_bf16 v[192:207], v[72:75], v[128:135], v14
    v_exp_f32 v140, v140
    v_exp_f32 v141, v141
    v_exp_f32 v142, v142
    v_exp_f32 v143, v143
    v_mfma_f32_32x32x8_bf16 v[96:111], v[62:63], v[20:21], 0
    v_exp_f32 v144, v144
    v_exp_f32 v145, v145
    v_exp_f32 v146, v146
    v_exp_f32 v147, v147
    v_mfma_f32_32x32x16_bf16 v[96:111], v[52:55], v[16:19], v[96:111]
    v_exp_f32 v148, v148
    v_exp_f32 v149, v149
    v_exp_f32 v150, v150
    v_exp_f32 v151, v151
    v_smfmac_f32_32x32x32_bf16 v[192:207], v[88:91], v[136:143], v14
    v_exp_f32 v152, v152
    v_exp_f32 v153, v153
    v_exp_f32 v154, v154
    v_exp_f32 v155, v155
    v_smfmac_f32_32x32x32_bf16 v[208:223], v[72:75], v[144:151], v14
    v_exp_f32 v156, v156
    v_exp_f32 v157, v157
    v_exp_f32 v158, v158
    v_exp_f32 v159, v159
    v_mfma_f32_32x32x8_bf16 v[112:127], v[62:63], v[26:27], 0
    v_exp_f32 v96, v96
    v_exp_f32 v97, v97
    v_exp_f32 v98, v98
    v_exp_f32 v99, v99
    v_mfma_f32_32x32x16_bf16 v[112:127], v[52:55], v[22:25], v[112:127]
    v_exp_f32 v100, v100
    v_exp_f32 v101, v101
    v_exp_f32 v102, v102
    v_exp_f32 v103, v103
    v_smfmac_f32_32x32x32_bf16 v[208:223], v[88:91], v[152:159], v14
    v_exp_f32 v104, v104
    v_exp_f32 v105, v105
    v_exp_f32 v106, v106
    v_exp_f32 v107, v107
    v_smfmac_f32_32x32x32_bf16 v[160:175], v[76:79], v[96:103], v14
    v_exp_f32 v108, v108
    v_exp_f32 v109, v109
    v_exp_f32 v110, v110
    v_exp_f32 v111, v111
    v_mfma_f32_32x32x8_bf16 v[128:143], v[62:63], v[32:33], 0
    v_exp_f32 v112, v112
    v_exp_f32 v113, v113
    v_exp_f32 v114, v114
    v_exp_f32 v115, v115
    v_mfma_f32_32x32x16_bf16 v[128:143], v[52:55], v[28:31], v[128:143]
    v_exp_f32 v116, v116
    v_exp_f32 v117, v117
    v_exp_f32 v118, v118
    v_exp_f32 v119, v119
    v_smfmac_f32_32x32x32_bf16 v[160:175], v[92:95], v[104:111], v14
    v_exp_f32 v120, v120
    v_exp_f32 v121, v121
    v_exp_f32 v122, v122
    v_exp_f32 v123, v123
    v_smfmac_f32_32x32x32_bf16 v[176:191], v[76:79], v[112:119], v14
    v_exp_f32 v124, v124
    v_exp_f32 v125, v125
    v_exp_f32 v126, v126
    v_exp_f32 v127, v127
    v_mfma_f32_32x32x8_bf16 v[144:159], v[62:63], v[38:39], 0
    v_exp_f32 v128, v128
    v_exp_f32 v129, v129
    v_exp_f32 v130, v130
    v_exp_f32 v131, v131
    v_mfma_f32_32x32x16_bf16 v[144:159], v[52:55], v[34:37], v[144:159]
    ds_write_b128 v252, v[160:163] offset:0
    v_exp_f32 v132, v132
    v_exp_f32 v133, v133
    v_exp_f32 v134, v134
    v_exp_f32 v135, v135
    v_smfmac_f32_32x32x32_bf16 v[176:191], v[92:95], v[120:127], v14
    ds_write_b128 v252, v[164:167] offset:1024
    v_exp_f32 v136, v136
    v_exp_f32 v137, v137
    v_exp_f32 v138, v138
    v_exp_f32 v139, v139
    v_smfmac_f32_32x32x32_bf16 v[192:207], v[76:79], v[128:135], v14
    ds_write_b96 v252, v[168:170] offset:2048
    v_exp_f32 v140, v140
    v_exp_f32 v141, v141
    v_exp_f32 v142, v142
    v_exp_f32 v143, v143
    v_exp_f32 v144, v144
    v_exp_f32 v145, v145
    v_exp_f32 v146, v146
    v_exp_f32 v147, v147
    ds_write_b128 v252, v[176:179] offset:3072
    v_exp_f32 v148, v148
    v_exp_f32 v149, v149
    v_exp_f32 v150, v150
    v_exp_f32 v151, v151
    v_smfmac_f32_32x32x32_bf16 v[192:207], v[92:95], v[136:143], v14
    ds_write_b128 v252, v[180:183] offset:4096
    v_exp_f32 v152, v152
    v_exp_f32 v153, v153
    v_exp_f32 v154, v154
    v_exp_f32 v155, v155
    v_smfmac_f32_32x32x32_bf16 v[208:223], v[76:79], v[144:151], v14
    ds_write_b96 v252, v[184:186] offset:5120
    v_exp_f32 v156, v156
    v_exp_f32 v157, v157
    v_exp_f32 v158, v158
    v_exp_f32 v159, v159
    s_cmp_ge_u32 s3, 4
    s_nop 0
    v_smfmac_f32_32x32x32_bf16 v[208:223], v[92:95], v[152:159], v14
    s_cbranch_scc0 L_aend
    s_setprio 2
    s_mov_b32 s96, 0x71800000
    s_mov_b32 s97, 0x7800000
    s_cmp_lg_u32 s40, 0
    s_cselect_b64 vcc, -1, 0
    s_cmp_eq_u32 s15, 0
    s_waitcnt lgkmcnt(0)
    s_barrier
    s_cbranch_vccnz L_bpub
    ds_read_b128 v[96:99], v255 offset:0
    ds_read_b128 v[100:103], v255 offset:1024
    ds_read_b128 v[104:107], v255 offset:2048
    ds_read_b128 v[108:111], v255 offset:24576
    ds_read_b128 v[112:115], v255 offset:25600
    ds_read_b128 v[116:119], v255 offset:26624
    ds_read_b128 v[120:123], v255 offset:3072
    ds_read_b128 v[124:127], v255 offset:4096
    ds_read_b128 v[128:131], v255 offset:5120
    ds_read_b128 v[132:135], v255 offset:27648
    ds_read_b128 v[136:139], v255 offset:28672
    ds_read_b128 v[140:143], v255 offset:29696
    s_waitcnt lgkmcnt(9)
    v_add_f32 v202, v202, v106
    v_pk_add_f32 v[192:193], v[192:193], v[96:97]
    v_pk_add_f32 v[194:195], v[194:195], v[98:99]
    v_pk_add_f32 v[196:197], v[196:197], v[100:101]
    v_pk_add_f32 v[198:199], v[198:199], v[102:103]
    v_pk_add_f32 v[200:201], v[200:201], v[104:105]
    s_waitcnt lgkmcnt(6)
    v_add_f32 v202, v202, v118
    v_pk_add_f32 v[192:193], v[192:193], v[108:109]
    v_rcp_f32 v204, v202
    v_pk_add_f32 v[194:195], v[194:195], v[110:111]
    v_pk_add_f32 v[196:197], v[196:197], v[112:113]
    v_pk_add_f32 v[198:199], v[198:199], v[114:115]
    v_pk_add_f32 v[200:201], v[200:201], v[116:117]
    v_pk_mul_f32 v[96:97], v[192:193], v[204:205] op_sel_hi:[1,0]
    v_pk_mul_f32 v[98:99], v[194:195], v[204:205] op_sel_hi:[1,0]
    v_pk_mul_f32 v[100:101], v[196:197], v[204:205] op_sel_hi:[1,0]
    v_pk_mul_f32 v[102:103], v[198:199], v[204:205] op_sel_hi:[1,0]
    v_pk_mul_f32 v[104:105], v[200:201], v[204:205] op_sel_hi:[1,0]
    v_cvt_pk_bf16_f32 v160, v96, v97
    v_cvt_pk_bf16_f32 v161, v98, v99
    v_cvt_pk_bf16_f32 v162, v100, v101
    v_cvt_pk_bf16_f32 v163, v102, v103
    v_cvt_pk_bf16_f32 v168, v104, v105
    s_cbranch_scc1 L_wt0
    buffer_store_dwordx4 v[160:163], v1, s[32:35], s12 offen offset:0
L_wtr0:
    s_waitcnt lgkmcnt(3)
    v_add_f32 v218, v218, v130
    v_pk_add_f32 v[208:209], v[208:209], v[120:121]
    v_pk_add_f32 v[210:211], v[210:211], v[122:123]
    v_pk_add_f32 v[212:213], v[212:213], v[124:125]
    v_pk_add_f32 v[214:215], v[214:215], v[126:127]
    v_pk_add_f32 v[216:217], v[216:217], v[128:129]
    s_waitcnt lgkmcnt(0)
    v_add_f32 v218, v218, v142
    v_pk_add_f32 v[208:209], v[208:209], v[132:133]
    v_rcp_f32 v220, v218
    v_pk_add_f32 v[210:211], v[210:211], v[134:135]
    v_pk_add_f32 v[212:213], v[212:213], v[136:137]
    v_pk_add_f32 v[214:215], v[214:215], v[138:139]
    v_pk_add_f32 v[216:217], v[216:217], v[140:141]
    v_pk_mul_f32 v[120:121], v[208:209], v[220:221] op_sel_hi:[1,0]
    v_pk_mul_f32 v[122:123], v[210:211], v[220:221] op_sel_hi:[1,0]
    v_pk_mul_f32 v[124:125], v[212:213], v[220:221] op_sel_hi:[1,0]
    v_pk_mul_f32 v[126:127], v[214:215], v[220:221] op_sel_hi:[1,0]
    v_pk_mul_f32 v[128:129], v[216:217], v[220:221] op_sel_hi:[1,0]
    v_cvt_pk_bf16_f32 v164, v120, v121
    v_cvt_pk_bf16_f32 v165, v122, v123
    v_cvt_pk_bf16_f32 v166, v124, v125
    v_cvt_pk_bf16_f32 v167, v126, v127
    v_cvt_pk_bf16_f32 v169, v128, v129
    s_cbranch_scc1 L_wt1
    buffer_store_dwordx4 v[164:167], v1, s[32:35], s12 offen offset:512
    buffer_store_dwordx2 v[168:169], v1, s[32:35], s13 offen
L_wtr1:
    v_max3_f32 v10, |v192|, |v193|, |v194|
    v_max3_f32 v10, |v195|, |v196|, v10
    v_max3_f32 v10, |v197|, |v198|, v10
    v_max3_f32 v10, |v199|, |v200|, v10
    v_max_f32_e64 v10, |v201|, v10
    v_max_f32 v15, v10, v202
    v_cmp_gt_f32 vcc, s96, v15
    v_cmp_lt_f32 s[58:59], s97, v10
    s_nop 0
    s_and_b64 vcc, vcc, s[58:59]
    s_cmp_eq_u64 vcc, -1
    s_cbranch_scc1 L_ok0
    s_cmp_eq_u32 s90, 0
    s_cbranch_scc1 L_bad
L_ok0:
    v_max3_f32 v10, |v208|, |v209|, |v210|
    v_max3_f32 v10, |v211|, |v212|, v10
    v_max3_f32 v10, |v213|, |v214|, v10
    v_max3_f32 v10, |v215|, |v216|, v10
    v_max_f32_e64 v10, |v217|, v10
    v_max_f32 v15, v10, v218
    v_cmp_gt_f32 vcc, s96, v15
    v_cmp_lt_f32 s[58:59], s97, v10
    s_nop 0
    s_and_b64 vcc, vcc, s[58:59]
    s_cmp_eq_u64 vcc, -1
    s_cbranch_scc1 L_ok1
    s_cmp_eq_u32 s90, 0
    s_cbranch_scc1 L_bad
L_ok1:
    v_mov_b32 v10, s84
    s_mov_b64 exec, 1
    s_cmp_eq_u32 s15, 0
    s_waitcnt vmcnt(0)
    s_cbranch_scc1 L_wt2
    buffer_store_dword v10, off, s[52:55], s14
L_wtr2:
    s_mov_b64 exec, -1
    s_mov_b32 s40, 1
L_bpub:
    v_and_b32 v12, 124, v6
    s_and_b32 s94, s14, -128
    s_barrier
    ds_read_b32 v11, v226 offset:4
    s_cmp_eq_u32 s3, 4
    s_cbranch_scc0 L_bnp
    buffer_load_dword v228, v12, s[52:55], s94 offen sc1
L_bnp:
    s_waitcnt lgkmcnt(0)
    v_readfirstlane_b32 s92, v11
    s_nop 0
    s_cmp_gt_u32 s92, s90
    s_cbranch_scc1 L_redo
    s_cmp_eq_u32 s3, 4
    s_cbranch_scc0 L_ordy
    s_mov_b32 s91, 1048576
    buffer_load_dword v229, v12, s[52:55], s94 offen sc1
    s_nop 15
    buffer_load_dword v230, v12, s[52:55], s94 offen sc1
L_ochk:
    s_waitcnt vmcnt(2)
    v_cmp_eq_u32 vcc, s84, v228
    s_nop 0
    s_cmp_eq_u64 vcc, -1
    s_cbranch_scc1 L_ordy
    buffer_load_dword v228, v12, s[52:55], s94 offen sc1
    s_waitcnt vmcnt(2)
    v_cmp_eq_u32 vcc, s84, v229
    s_nop 0
    s_cmp_eq_u64 vcc, -1
    s_cbranch_scc1 L_ordy
    buffer_load_dword v229, v12, s[52:55], s94 offen sc1
    s_waitcnt vmcnt(2)
    v_cmp_eq_u32 vcc, s84, v230
    s_nop 0
    s_cmp_eq_u64 vcc, -1
    s_cbranch_scc1 L_ordy
    buffer_load_dword v230, v12, s[52:55], s94 offen sc1
    s_sub_u32 s91, s91, 1
    s_cbranch_scc0 L_ochk
L_ordy:
    s_barrier
    s_branch L_fin
L_wt0:
    buffer_store_dwordx4 v[160:163], v1, s[32:35], s12 offen offset:0 sc1
    s_branch L_wtr0
L_wt1:
    buffer_store_dwordx4 v[164:167], v1, s[32:35], s12 offen offset:512 sc1
    buffer_store_dwordx2 v[168:169], v1, s[32:35], s13 offen sc1
    s_branch L_wtr1
L_wt2:
    buffer_store_dword v10, off, s[52:55], s14 sc1
    s_branch L_wtr2
L_aend:
    s_add_u32 s94, s90, 1
    s_waitcnt lgkmcnt(0)
    s_mov_b64 exec, 1
    ds_add_u32 v224, v227 offset:0
    s_mov_b64 exec, -1
    s_lshl2_add_u32 s92, s4, s3
    s_lshr_b32 s95, s56, 4
    s_cmp_eq_u32 s92, s95
    s_cselect_b32 s95, 1, 0
    s_cbranch_scc0 L_noy
    v_min_u32 v1, 624, v5
    s_mul_i32 s96, s5, 640
    s_add_u32 s96, s96, 176128
    s_add_u32 s58, s96, 0
    buffer_load_dwordx4 v[100:103], v1, s[52:55], s58 offen sc1
    s_add_u32 s58, s96, 5120
    buffer_load_dwordx4 v[104:107], v1, s[52:55], s58 offen sc1
    s_add_u32 s58, s96, 10240
    buffer_load_dwordx4 v[108:111], v1, s[52:55], s58 offen sc1
    s_add_u32 s58, s96, 15360
    buffer_load_dwordx4 v[112:115], v1, s[52:55], s58 offen sc1
L_noy:
    s_mov_b32 s91, 1048576
L_apair:
    ds_read_b32 v15, v225
    ds_read_b128 v[160:163], v253 offset:0
    ds_read_b128 v[164:167], v253 offset:1024
    ds_read_b128 v[168:171], v253 offset:2048
    ds_read_b128 v[172:175], v253 offset:3072
    ds_read_b128 v[176:179], v253 offset:4096
    ds_read_b128 v[180:183], v253 offset:5120
    s_waitcnt lgkmcnt(5)
    v_readfirstlane_b32 s97, v15
    s_nop 0
    s_cmp_lt_u32 s97, s94
    s_cbranch_scc1 L_await
L_agot:
    s_waitcnt lgkmcnt(5)
    v_add_f32 v192, v192, v160
    v_add_f32 v193, v193, v161
    v_add_f32 v194, v194, v162
    v_add_f32 v195, v195, v163
    ds_write_b128 v253, v[192:195] offset:0
    s_waitcnt lgkmcnt(5)
    v_add_f32 v196, v196, v164
    v_add_f32 v197, v197, v165
    v_add_f32 v198, v198, v166
    v_add_f32 v199, v199, v167
    ds_write_b128 v253, v[196:199] offset:1024
    s_waitcnt lgkmcnt(5)
    v_add_f32 v200, v200, v168
    v_add_f32 v201, v201, v169
    v_add_f32 v202, v202, v170
    ds_write_b96 v253, v[200:202] offset:2048
    s_waitcnt lgkmcnt(5)
    v_add_f32 v208, v208, v172
    v_add_f32 v209, v209, v173
    v_add_f32 v210, v210, v174
    v_add_f32 v211, v211, v175
    ds_write_b128 v253, v[208:211] offset:3072
    s_waitcnt lgkmcnt(5)
    v_add_f32 v212, v212, v176
    v_add_f32 v213, v213, v177
    v_add_f32 v214, v214, v178
    v_add_f32 v215, v215, v179
    ds_write_b128 v253, v[212:215] offset:4096
    s_waitcnt lgkmcnt(5)
    v_add_f32 v216, v216, v180
    v_add_f32 v217, v217, v181
    v_add_f32 v218, v218, v182
    ds_write_b96 v253, v[216:218] offset:5120
    s_cmp_lg_u32 s95, 0
    s_cbranch_scc1 L_yget
L_ygot:
    s_waitcnt vmcnt(0) lgkmcnt(0)
    s_barrier
    s_setprio 0
    v_lshrrev_b32 v10, 5, v0
    v_lshlrev_b32 v10, 4, v10
    v_bfe_u32 v11, v0, 2, 3
    v_add_u32 v10, v10, v11
    v_and_b32 v11, 3, v0
    v_lshl_add_u32 v10, v10, 2, v11
    v_mul_u32_u24 v10, 40, v10
    v_add_u32 v11, 51200, v10
    v_mov_b32 v15, 161280
    v_mul_f32 v250, 0xbfb8aa3b, v250
    v_exp_f32 v250, v250
    s_mul_i32 s92, s92, 20480
    s_mul_i32 s93, s5, 160
    s_add_u32 s93, s93, s92
    v_add_f32 v250, 1.0, v250
    v_rcp_f32 v250, v250
    s_nop 0
    v_sub_f32 v251, 1.0, v250
    s_add_u32 s95, s92, 16384
    s_add_u32 s24, s5, 0
    s_and_b32 s24, s24, 7
    s_lshl_b32 s24, s24, 11
    s_add_u32 s24, s24, s92
    s_add_u32 s25, s5, 1
    s_and_b32 s25, s25, 7
    s_lshl_b32 s25, s25, 11
    s_add_u32 s25, s25, s92
    s_add_u32 s26, s5, 2
    s_and_b32 s26, s26, 7
    s_lshl_b32 s26, s26, 11
    s_add_u32 s26, s26, s92
    s_add_u32 s27, s5, 3
    s_and_b32 s27, s27, 7
    s_lshl_b32 s27, s27, 11
    s_add_u32 s27, s27, s92
    s_add_u32 s28, s5, 4
    s_and_b32 s28, s28, 7
    s_lshl_b32 s28, s28, 11
    s_add_u32 s28, s28, s92
    s_add_u32 s29, s5, 5
    s_and_b32 s29, s29, 7
    s_lshl_b32 s29, s29, 11
    s_add_u32 s29, s29, s92
    s_add_u32 s30, s5, 6
    s_and_b32 s30, s30, 7
    s_lshl_b32 s30, s30, 11
    s_add_u32 s30, s30, s92
    s_add_u32 s31, s5, 7
    s_and_b32 s31, s31, 7
    s_lshl_b32 s31, s31, 11
    s_add_u32 s31, s31, s92
    ds_read_b64_tr_b16 v[120:121], v10 offset:0
    ds_read_b64_tr_b16 v[122:123], v10 offset:1280
    ds_read_b64_tr_b16 v[124:125], v10 offset:8
    ds_read_b64_tr_b16 v[126:127], v10 offset:1288
    ds_read_b64_tr_b16 v[128:129], v10 offset:16
    ds_read_b64_tr_b16 v[130:131], v10 offset:1296
    ds_read_b64_tr_b16 v[132:133], v10 offset:24
    ds_read_b64_tr_b16 v[134:135], v10 offset:1304
    ds_read_b64_tr_b16 v[136:137], v10 offset:32
    ds_read_b64_tr_b16 v[138:139], v10 offset:1312
    ds_read_b64_tr_b16 v[140:141], v10 offset:5120
    ds_read_b64_tr_b16 v[142:143], v10 offset:6400
    ds_read_b64_tr_b16 v[144:145], v10 offset:5128
    ds_read_b64_tr_b16 v[146:147], v10 offset:6408
    ds_read_b64_tr_b16 v[148:149], v10 offset:5136
    ds_read_b64_tr_b16 v[150:151], v10 offset:6416
    ds_read_b64_tr_b16 v[152:153], v10 offset:5144
    ds_read_b64_tr_b16 v[154:155], v10 offset:6424
    ds_read_b64_tr_b16 v[156:157], v10 offset:5152
    ds_read_b64_tr_b16 v[158:159], v10 offset:6432
    ds_read_b64_tr_b16 v[160:161], v10 offset:10240
    ds_read_b64_tr_b16 v[162:163], v10 offset:11520
    ds_read_b64_tr_b16 v[164:165], v10 offset:10248
    ds_read_b64_tr_b16 v[166:167], v10 offset:11528
    ds_read_b64_tr_b16 v[168:169], v10 offset:10256
    ds_read_b64_tr_b16 v[170:171], v10 offset:11536
    ds_read_b64_tr_b16 v[172:173], v10 offset:10264
    ds_read_b64_tr_b16 v[174:175], v10 offset:11544
    ds_read_b64_tr_b16 v[176:177], v10 offset:10272
    ds_read_b64_tr_b16 v[178:179], v10 offset:11552
    ds_read_b64_tr_b16 v[180:181], v10 offset:15360
    ds_read_b64_tr_b16 v[182:183], v10 offset:16640
    ds_read_b64_tr_b16 v[184:185], v10 offset:15368
    ds_read_b64_tr_b16 v[186:187], v10 offset:16648
    ds_read_b64_tr_b16 v[188:189], v10 offset:15376
    ds_read_b64_tr_b16 v[190:191], v10 offset:16656
    ds_read_b64_tr_b16 v[192:193], v10 offset:15384
    ds_read_b64_tr_b16 v[194:195], v10 offset:16664
    ds_read_b64_tr_b16 v[196:197], v10 offset:15392
    ds_read_b64_tr_b16 v[198:199], v10 offset:16672
    ds_read_b64_tr_b16 v[200:201], v10 offset:20480
    ds_read_b64_tr_b16 v[202:203], v10 offset:21760
    ds_read_b64_tr_b16 v[204:205], v10 offset:20488
    ds_read_b64_tr_b16 v[206:207], v10 offset:21768
    ds_read_b64_tr_b16 v[208:209], v10 offset:20496
    ds_read_b64_tr_b16 v[210:211], v10 offset:21776
    ds_read_b64_tr_b16 v[212:213], v10 offset:20504
    ds_read_b64_tr_b16 v[214:215], v10 offset:21784
    ds_read_b64_tr_b16 v[216:217], v10 offset:20512
    ds_read_b64_tr_b16 v[218:219], v10 offset:21792
    ds_read_b64_tr_b16 v[220:221], v10 offset:25600
    ds_read_b64_tr_b16 v[222:223], v10 offset:26880
    ds_read_b64_tr_b16 v[224:225], v10 offset:25608
    ds_read_b64_tr_b16 v[226:227], v10 offset:26888
    ds_read_b64_tr_b16 v[228:229], v10 offset:25616
    ds_read_b64_tr_b16 v[230:231], v10 offset:26896
    ds_read_b64_tr_b16 v[232:233], v10 offset:25624
    ds_read_b64_tr_b16 v[234:235], v10 offset:26904
    ds_read_b64_tr_b16 v[236:237], v10 offset:25632
    ds_read_b64_tr_b16 v[238:239], v10 offset:26912
    s_barrier
    ds_read_b32 v15, v15 offset:4
    s_waitcnt lgkmcnt(0)
    v_readfirstlane_b32 s96, v15
    s_nop 0
    s_cmp_gt_u32 s96, s90
    s_cbranch_scc1 L_redo
    buffer_load_dwordx4 v[60:63], v5, s[32:35], s24 offen offset:0 sc1
    buffer_load_dwordx4 v[64:67], v5, s[32:35], s24 offen offset:1024 sc1
    ds_read_b64_tr_b16 v[16:17], v10 offset:30720
    ds_read_b64_tr_b16 v[18:19], v10 offset:32000
    ds_read_b64_tr_b16 v[20:21], v10 offset:30728
    ds_read_b64_tr_b16 v[22:23], v10 offset:32008
    ds_read_b64_tr_b16 v[24:25], v10 offset:30736
    ds_read_b64_tr_b16 v[26:27], v10 offset:32016
    ds_read_b64_tr_b16 v[28:29], v10 offset:30744
    ds_read_b64_tr_b16 v[30:31], v10 offset:32024
    ds_read_b64_tr_b16 v[32:33], v10 offset:30752
    ds_read_b64_tr_b16 v[34:35], v10 offset:32032
    s_mul_i32 s96, s3, 3072
    s_add_u32 s96, s96, 102400
    v_lshl_add_u32 v12, v7, 2, v8
    v_mul_u32_u24 v12, 40, v12
    v_add_u32 v12, s96, v12
    v_add_u32 v13, s96, v5
    s_mov_b32 s97, 0x1999999a
    v_add_u32 v15, 0, v0
    v_mul_hi_u32 v253, v15, s97
    v_mul_u32_u24 v253, 1120, v253
    v_lshl_add_u32 v1, v15, 4, v253
    v_add_u32 v15, 64, v0
    v_mul_hi_u32 v253, v15, s97
    v_mul_u32_u24 v253, 1120, v253
    v_lshl_add_u32 v9, v15, 4, v253
    v_add_u32 v15, 128, v0
    v_mul_hi_u32 v253, v15, s97
    v_mul_u32_u24 v253, 1120, v253
    v_lshl_add_u32 v255, v15, 4, v253
    v_cmp_gt_u32 vcc, 32, v0
    v_mov_b32 v15, 0x7000000
    s_nop 0
    v_cndmask_b32 v255, v15, v255, vcc
    v_and_b32 v253, 28, v6
    v_mov_b32 v14, s84
    s_lshl2_add_u32 s96, s5, s14
    s_barrier
    buffer_load_dwordx4 v[68:71], v5, s[32:35], s25 offen offset:0 sc1
    buffer_load_dwordx4 v[72:75], v5, s[32:35], s25 offen offset:1024 sc1
    s_waitcnt vmcnt(3)
    v_mfma_f32_16x16x32_bf16 v[40:43], v[120:123], v[60:63], 0
    ds_read_b64_tr_b16 v[120:121], v10 offset:35840
    ds_read_b64_tr_b16 v[122:123], v10 offset:37120
    v_mfma_f32_16x16x32_bf16 v[44:47], v[124:127], v[60:63], 0
    buffer_load_dwordx4 v[76:79], v5, s[32:35], s26 offen offset:0 sc1
    ds_read_b64_tr_b16 v[124:125], v10 offset:35848
    ds_read_b64_tr_b16 v[126:127], v10 offset:37128
    v_mfma_f32_16x16x32_bf16 v[48:51], v[128:131], v[60:63], 0
    ds_read_b64_tr_b16 v[128:129], v10 offset:35856
    ds_read_b64_tr_b16 v[130:131], v10 offset:37136
    v_mfma_f32_16x16x32_bf16 v[52:55], v[132:135], v[60:63], 0
    ds_read_b64_tr_b16 v[132:133], v10 offset:35864
    ds_read_b64_tr_b16 v[134:135], v10 offset:37144
    v_mfma_f32_16x16x32_bf16 v[56:59], v[136:139], v[60:63], 0
    buffer_load_dwordx4 v[80:83], v5, s[32:35], s26 offen offset:1024 sc1
    ds_read_b64_tr_b16 v[136:137], v10 offset:35872
    ds_read_b64_tr_b16 v[138:139], v10 offset:37152
    s_waitcnt vmcnt(4)
    v_mfma_f32_16x16x32_bf16 v[40:43], v[140:143], v[64:67], v[40:43]
    ds_read_b64_tr_b16 v[140:141], v10 offset:40960
    ds_read_b64_tr_b16 v[142:143], v10 offset:42240
    v_mfma_f32_16x16x32_bf16 v[44:47], v[144:147], v[64:67], v[44:47]
    buffer_load_dwordx4 v[84:87], v5, s[32:35], s27 offen offset:0 sc1
    ds_read_b64_tr_b16 v[144:145], v10 offset:40968
    ds_read_b64_tr_b16 v[146:147], v10 offset:42248
    v_mfma_f32_16x16x32_bf16 v[48:51], v[148:151], v[64:67], v[48:51]
    ds_read_b64_tr_b16 v[148:149], v10 offset:40976
    ds_read_b64_tr_b16 v[150:151], v10 offset:42256
    v_mfma_f32_16x16x32_bf16 v[52:55], v[152:155], v[64:67], v[52:55]
    ds_read_b64_tr_b16 v[152:153], v10 offset:40984
    ds_read_b64_tr_b16 v[154:155], v10 offset:42264
    v_mfma_f32_16x16x32_bf16 v[56:59], v[156:159], v[64:67], v[56:59]
    buffer_load_dwordx4 v[88:91], v5, s[32:35], s27 offen offset:1024 sc1
    ds_read_b64_tr_b16 v[156:157], v10 offset:40992
    ds_read_b64_tr_b16 v[158:159], v10 offset:42272
    s_waitcnt vmcnt(5)
    v_mfma_f32_16x16x32_bf16 v[40:43], v[160:163], v[68:71], v[40:43]
    ds_read_b64_tr_b16 v[160:161], v10 offset:46080
    ds_read_b64_tr_b16 v[162:163], v10 offset:47360
    v_mfma_f32_16x16x32_bf16 v[44:47], v[164:167], v[68:71], v[44:47]
    ds_read_b64_tr_b16 v[164:165], v10 offset:46088
    ds_read_b64_tr_b16 v[166:167], v10 offset:47368
    v_mfma_f32_16x16x32_bf16 v[48:51], v[168:171], v[68:71], v[48:51]
    ds_read_b64_tr_b16 v[168:169], v10 offset:46096
    ds_read_b64_tr_b16 v[170:171], v10 offset:47376
    v_mfma_f32_16x16x32_bf16 v[52:55], v[172:175], v[68:71], v[52:55]
    ds_read_b64_tr_b16 v[172:173], v10 offset:46104
    ds_read_b64_tr_b16 v[174:175], v10 offset:47384
    v_mfma_f32_16x16x32_bf16 v[56:59], v[176:179], v[68:71], v[56:59]
    buffer_load_dwordx4 v[92:95], v5, s[32:35], s28 offen offset:0 sc1
    s_waitcnt vmcnt(5)
    v_mfma_f32_16x16x32_bf16 v[40:43], v[180:183], v[72:75], v[40:43]
    ds_read_b64_tr_b16 v[176:177], v10 offset:46112
    ds_read_b64_tr_b16 v[178:179], v10 offset:47392
    v_mfma_f32_16x16x32_bf16 v[44:47], v[184:187], v[72:75], v[44:47]
    ds_read_b64_tr_b16 v[180:181], v11 offset:0
    ds_read_b64_tr_b16 v[182:183], v11 offset:1280
    v_mfma_f32_16x16x32_bf16 v[48:51], v[188:191], v[72:75], v[48:51]
    ds_read_b64_tr_b16 v[184:185], v11 offset:8
    ds_read_b64_tr_b16 v[186:187], v11 offset:1288
    v_mfma_f32_16x16x32_bf16 v[52:55], v[192:195], v[72:75], v[52:55]
    ds_read_b64_tr_b16 v[188:189], v11 offset:16
    ds_read_b64_tr_b16 v[190:191], v11 offset:1296
    v_mfma_f32_16x16x32_bf16 v[56:59], v[196:199], v[72:75], v[56:59]
    buffer_load_dwordx4 v[96:99], v5, s[32:35], s28 offen offset:1024 sc1
    s_waitcnt vmcnt(5)
    v_mfma_f32_16x16x32_bf16 v[40:43], v[200:203], v[76:79], v[40:43]
    ds_read_b64_tr_b16 v[192:193], v11 offset:24
    ds_read_b64_tr_b16 v[194:195], v11 offset:1304
    v_mfma_f32_16x16x32_bf16 v[44:47], v[204:207], v[76:79], v[44:47]
    ds_read_b64_tr_b16 v[196:197], v11 offset:32
    ds_read_b64_tr_b16 v[198:199], v11 offset:1312
    v_mfma_f32_16x16x32_bf16 v[48:51], v[208:211], v[76:79], v[48:51]
    ds_read_b64_tr_b16 v[200:201], v11 offset:5120
    ds_read_b64_tr_b16 v[202:203], v11 offset:6400
    v_mfma_f32_16x16x32_bf16 v[52:55], v[212:215], v[76:79], v[52:55]
    ds_read_b64_tr_b16 v[204:205], v11 offset:5128
    ds_read_b64_tr_b16 v[206:207], v11 offset:6408
    v_mfma_f32_16x16x32_bf16 v[56:59], v[216:219], v[76:79], v[56:59]
    buffer_load_dwordx4 v[100:103], v5, s[32:35], s29 offen offset:0 sc1
    s_waitcnt vmcnt(5)
    v_mfma_f32_16x16x32_bf16 v[40:43], v[220:223], v[80:83], v[40:43]
    ds_read_b64_tr_b16 v[208:209], v11 offset:5136
    ds_read_b64_tr_b16 v[210:211], v11 offset:6416
    v_mfma_f32_16x16x32_bf16 v[44:47], v[224:227], v[80:83], v[44:47]
    ds_read_b64_tr_b16 v[212:213], v11 offset:5144
    ds_read_b64_tr_b16 v[214:215], v11 offset:6424
    v_mfma_f32_16x16x32_bf16 v[48:51], v[228:231], v[80:83], v[48:51]
    ds_read_b64_tr_b16 v[216:217], v11 offset:5152
    ds_read_b64_tr_b16 v[218:219], v11 offset:6432
    v_mfma_f32_16x16x32_bf16 v[52:55], v[232:235], v[80:83], v[52:55]
    ds_read_b64_tr_b16 v[220:221], v11 offset:10240
    ds_read_b64_tr_b16 v[222:223], v11 offset:11520
    v_mfma_f32_16x16x32_bf16 v[56:59], v[236:239], v[80:83], v[56:59]
    buffer_load_dwordx4 v[104:107], v5, s[32:35], s29 offen offset:1024 sc1
    s_waitcnt vmcnt(5) lgkmcnt(14)
    v_mfma_f32_16x16x32_bf16 v[40:43], v[16:19], v[84:87], v[40:43]
    ds_read_b64_tr_b16 v[224:225], v11 offset:10248
    ds_read_b64_tr_b16 v[226:227], v11 offset:11528
    v_mfma_f32_16x16x32_bf16 v[44:47], v[20:23], v[84:87], v[44:47]
    ds_read_b64_tr_b16 v[228:229], v11 offset:10256
    ds_read_b64_tr_b16 v[230:231], v11 offset:11536
    v_mfma_f32_16x16x32_bf16 v[48:51], v[24:27], v[84:87], v[48:51]
    ds_read_b64_tr_b16 v[232:233], v11 offset:10264
    ds_read_b64_tr_b16 v[234:235], v11 offset:11544
    v_mfma_f32_16x16x32_bf16 v[52:55], v[28:31], v[84:87], v[52:55]
    ds_read_b64_tr_b16 v[236:237], v11 offset:10272
    ds_read_b64_tr_b16 v[238:239], v11 offset:11552
    v_mfma_f32_16x16x32_bf16 v[56:59], v[32:35], v[84:87], v[56:59]
    buffer_load_dwordx4 v[108:111], v5, s[32:35], s30 offen offset:0 sc1
    buffer_load_dwordx4 v[112:115], v5, s[32:35], s30 offen offset:1024 sc1
    s_waitcnt vmcnt(6)
    v_mfma_f32_16x16x32_bf16 v[40:43], v[120:123], v[88:91], v[40:43]
    ds_read_b64_tr_b16 v[16:17], v11 offset:15360
    ds_read_b64_tr_b16 v[18:19], v11 offset:16640
    v_mfma_f32_16x16x32_bf16 v[44:47], v[124:127], v[88:91], v[44:47]
    ds_read_b64_tr_b16 v[20:21], v11 offset:15368
    ds_read_b64_tr_b16 v[22:23], v11 offset:16648
    v_mfma_f32_16x16x32_bf16 v[48:51], v[128:131], v[88:91], v[48:51]
    ds_read_b64_tr_b16 v[24:25], v11 offset:15376
    ds_read_b64_tr_b16 v[26:27], v11 offset:16656
    v_mfma_f32_16x16x32_bf16 v[52:55], v[132:135], v[88:91], v[52:55]
    ds_read_b64_tr_b16 v[28:29], v11 offset:15384
    ds_read_b64_tr_b16 v[30:31], v11 offset:16664
    v_mfma_f32_16x16x32_bf16 v[56:59], v[136:139], v[88:91], v[56:59]
    buffer_load_dwordx4 v[116:119], v5, s[32:35], s31 offen offset:0 sc1
    buffer_load_dwordx4 v[60:63], v5, s[32:35], s31 offen offset:1024 sc1
    s_waitcnt vmcnt(7)
    v_mfma_f32_16x16x32_bf16 v[40:43], v[140:143], v[92:95], v[40:43]
    ds_read_b64_tr_b16 v[32:33], v11 offset:15392
    ds_read_b64_tr_b16 v[34:35], v11 offset:16672
    v_mfma_f32_16x16x32_bf16 v[44:47], v[144:147], v[92:95], v[44:47]
    ds_read_b64_tr_b16 v[120:121], v11 offset:20480
    ds_read_b64_tr_b16 v[122:123], v11 offset:21760
    v_mfma_f32_16x16x32_bf16 v[48:51], v[148:151], v[92:95], v[48:51]
    ds_read_b64_tr_b16 v[124:125], v11 offset:20488
    ds_read_b64_tr_b16 v[126:127], v11 offset:21768
    v_mfma_f32_16x16x32_bf16 v[52:55], v[152:155], v[92:95], v[52:55]
    ds_read_b64_tr_b16 v[128:129], v11 offset:20496
    ds_read_b64_tr_b16 v[130:131], v11 offset:21776
    v_mfma_f32_16x16x32_bf16 v[56:59], v[156:159], v[92:95], v[56:59]
    buffer_load_dwordx4 v[64:67], v5, s[32:35], s95 offen offset:0 sc1
    buffer_load_dwordx4 v[68:71], v5, s[32:35], s95 offen offset:1024 sc1
    s_waitcnt vmcnt(8)
    v_mfma_f32_16x16x32_bf16 v[40:43], v[160:163], v[96:99], v[40:43]
    ds_read_b64_tr_b16 v[132:133], v11 offset:20504
    ds_read_b64_tr_b16 v[134:135], v11 offset:21784
    v_mfma_f32_16x16x32_bf16 v[44:47], v[164:167], v[96:99], v[44:47]
    ds_read_b64_tr_b16 v[136:137], v11 offset:20512
    ds_read_b64_tr_b16 v[138:139], v11 offset:21792
    v_mfma_f32_16x16x32_bf16 v[48:51], v[168:171], v[96:99], v[48:51]
    ds_read_b64_tr_b16 v[140:141], v11 offset:25600
    ds_read_b64_tr_b16 v[142:143], v11 offset:26880
    v_mfma_f32_16x16x32_bf16 v[52:55], v[172:175], v[96:99], v[52:55]
    ds_read_b64_tr_b16 v[144:145], v11 offset:25608
    ds_read_b64_tr_b16 v[146:147], v11 offset:26888
    v_mfma_f32_16x16x32_bf16 v[56:59], v[176:179], v[96:99], v[56:59]
    buffer_load_dwordx4 v[72:75], v5, s[32:35], s95 offen offset:2048 sc1
    buffer_load_dwordx4 v[76:79], v5, s[32:35], s95 offen offset:3072 sc1
    s_waitcnt vmcnt(9) lgkmcnt(14)
    v_mfma_f32_16x16x32_bf16 v[40:43], v[180:183], v[100:103], v[40:43]
    ds_read_b64_tr_b16 v[148:149], v11 offset:25616
    ds_read_b64_tr_b16 v[150:151], v11 offset:26896
    v_mfma_f32_16x16x32_bf16 v[44:47], v[184:187], v[100:103], v[44:47]
    ds_read_b64_tr_b16 v[152:153], v11 offset:25624
    ds_read_b64_tr_b16 v[154:155], v11 offset:26904
    v_mfma_f32_16x16x32_bf16 v[48:51], v[188:191], v[100:103], v[48:51]
    ds_read_b64_tr_b16 v[156:157], v11 offset:25632
    ds_read_b64_tr_b16 v[158:159], v11 offset:26912
    v_mfma_f32_16x16x32_bf16 v[52:55], v[192:195], v[100:103], v[52:55]
    ds_read_b64_tr_b16 v[160:161], v11 offset:30720
    ds_read_b64_tr_b16 v[162:163], v11 offset:32000
    v_mfma_f32_16x16x32_bf16 v[56:59], v[196:199], v[100:103], v[56:59]
    v_lshlrev_b32 v80, 16, v240
    v_and_b32 v81, 0xffff0000, v240
    s_waitcnt vmcnt(8)
    v_mfma_f32_16x16x32_bf16 v[40:43], v[200:203], v[104:107], v[40:43]
    ds_read_b64_tr_b16 v[164:165], v11 offset:30728
    ds_read_b64_tr_b16 v[166:167], v11 offset:32008
    v_mfma_f32_16x16x32_bf16 v[44:47], v[204:207], v[104:107], v[44:47]
    ds_read_b64_tr_b16 v[168:169], v11 offset:30736
    ds_read_b64_tr_b16 v[170:171], v11 offset:32016
    v_mfma_f32_16x16x32_bf16 v[48:51], v[208:211], v[104:107], v[48:51]
    ds_read_b64_tr_b16 v[172:173], v11 offset:30744
    ds_read_b64_tr_b16 v[174:175], v11 offset:32024
    v_mfma_f32_16x16x32_bf16 v[52:55], v[212:215], v[104:107], v[52:55]
    ds_read_b64_tr_b16 v[176:177], v11 offset:30752
    ds_read_b64_tr_b16 v[178:179], v11 offset:32032
    v_mfma_f32_16x16x32_bf16 v[56:59], v[216:219], v[104:107], v[56:59]
    v_mul_f32 v80, v251, v80
    v_mul_f32 v81, v251, v81
    s_waitcnt vmcnt(7)
    v_mfma_f32_16x16x32_bf16 v[40:43], v[220:223], v[108:111], v[40:43]
    ds_read_b64_tr_b16 v[180:181], v11 offset:35840
    ds_read_b64_tr_b16 v[182:183], v11 offset:37120
    v_mfma_f32_16x16x32_bf16 v[44:47], v[224:227], v[108:111], v[44:47]
    ds_read_b64_tr_b16 v[184:185], v11 offset:35848
    ds_read_b64_tr_b16 v[186:187], v11 offset:37128
    v_mfma_f32_16x16x32_bf16 v[48:51], v[228:231], v[108:111], v[48:51]
    ds_read_b64_tr_b16 v[188:189], v11 offset:35856
    ds_read_b64_tr_b16 v[190:191], v11 offset:37136
    v_mfma_f32_16x16x32_bf16 v[52:55], v[232:235], v[108:111], v[52:55]
    ds_read_b64_tr_b16 v[192:193], v11 offset:35864
    ds_read_b64_tr_b16 v[194:195], v11 offset:37144
    v_mfma_f32_16x16x32_bf16 v[56:59], v[236:239], v[108:111], v[56:59]
    v_lshlrev_b32 v82, 16, v241
    v_and_b32 v83, 0xffff0000, v241
    s_waitcnt vmcnt(6)
    v_mfma_f32_16x16x32_bf16 v[40:43], v[16:19], v[112:115], v[40:43]
    ds_read_b64_tr_b16 v[196:197], v11 offset:35872
    ds_read_b64_tr_b16 v[198:199], v11 offset:37152
    v_mfma_f32_16x16x32_bf16 v[44:47], v[20:23], v[112:115], v[44:47]
    ds_read_b64_tr_b16 v[200:201], v11 offset:40960
    ds_read_b64_tr_b16 v[202:203], v11 offset:42240
    v_mfma_f32_16x16x32_bf16 v[48:51], v[24:27], v[112:115], v[48:51]
    ds_read_b64_tr_b16 v[204:205], v11 offset:40968
    ds_read_b64_tr_b16 v[206:207], v11 offset:42248
    v_mfma_f32_16x16x32_bf16 v[52:55], v[28:31], v[112:115], v[52:55]
    ds_read_b64_tr_b16 v[208:209], v11 offset:40976
    ds_read_b64_tr_b16 v[210:211], v11 offset:42256
    v_mfma_f32_16x16x32_bf16 v[56:59], v[32:35], v[112:115], v[56:59]
    v_mul_f32 v82, v251, v82
    v_mul_f32 v83, v251, v83
    s_waitcnt vmcnt(5) lgkmcnt(14)
    v_mfma_f32_16x16x32_bf16 v[40:43], v[120:123], v[116:119], v[40:43]
    ds_read_b64_tr_b16 v[212:213], v11 offset:40984
    ds_read_b64_tr_b16 v[214:215], v11 offset:42264
    v_mfma_f32_16x16x32_bf16 v[44:47], v[124:127], v[116:119], v[44:47]
    ds_read_b64_tr_b16 v[216:217], v11 offset:40992
    ds_read_b64_tr_b16 v[218:219], v11 offset:42272
    v_mfma_f32_16x16x32_bf16 v[48:51], v[128:131], v[116:119], v[48:51]
    ds_read_b64_tr_b16 v[220:221], v11 offset:46080
    ds_read_b64_tr_b16 v[222:223], v11 offset:47360
    v_mfma_f32_16x16x32_bf16 v[52:55], v[132:135], v[116:119], v[52:55]
    ds_read_b64_tr_b16 v[224:225], v11 offset:46088
    ds_read_b64_tr_b16 v[226:227], v11 offset:47368
    v_mfma_f32_16x16x32_bf16 v[56:59], v[136:139], v[116:119], v[56:59]
    v_lshlrev_b32 v84, 16, v242
    v_and_b32 v85, 0xffff0000, v242
    s_waitcnt vmcnt(0)
    v_mfma_f32_16x16x32_bf16 v[40:43], v[140:143], v[60:63], v[40:43]
    ds_read_b64_tr_b16 v[228:229], v11 offset:46096
    ds_read_b64_tr_b16 v[230:231], v11 offset:47376
    v_mfma_f32_16x16x32_bf16 v[44:47], v[144:147], v[60:63], v[44:47]
    ds_read_b64_tr_b16 v[232:233], v11 offset:46104
    ds_read_b64_tr_b16 v[234:235], v11 offset:47384
    v_mfma_f32_16x16x32_bf16 v[48:51], v[148:151], v[60:63], v[48:51]
    ds_read_b64_tr_b16 v[236:237], v11 offset:46112
    ds_read_b64_tr_b16 v[238:239], v11 offset:47392
    v_mfma_f32_16x16x32_bf16 v[52:55], v[152:155], v[60:63], v[52:55]
    v_mul_f32 v84, v251, v84
    v_mul_f32 v85, v251, v85
    v_mfma_f32_16x16x32_bf16 v[56:59], v[156:159], v[60:63], v[56:59]
    buffer_store_dword v14, off, s[52:55], s96
    v_lshlrev_b32 v86, 16, v243
    v_and_b32 v87, 0xffff0000, v243
    s_waitcnt lgkmcnt(0)
    v_mfma_f32_16x16x32_bf16 v[40:43], v[160:163], v[64:67], v[40:43]
    v_mul_f32 v86, v251, v86
    v_mul_f32 v87, v251, v87
    v_lshlrev_b32 v88, 16, v244
    v_mfma_f32_16x16x32_bf16 v[40:43], v[180:183], v[68:71], v[40:43]
    v_and_b32 v89, 0xffff0000, v244
    v_mul_f32 v88, v251, v88
    v_mul_f32 v89, v251, v89
    v_mfma_f32_16x16x32_bf16 v[40:43], v[200:203], v[72:75], v[40:43]
    v_lshlrev_b32 v90, 16, v245
    v_and_b32 v91, 0xffff0000, v245
    v_mul_f32 v90, v251, v90
    v_mfma_f32_16x16x32_bf16 v[40:43], v[220:223], v[76:79], v[40:43]
    v_mul_f32 v91, v251, v91
    v_lshlrev_b32 v92, 16, v246
    v_and_b32 v93, 0xffff0000, v246
    v_mfma_f32_16x16x32_bf16 v[44:47], v[164:167], v[64:67], v[44:47]
    v_mul_f32 v92, v251, v92
    v_mul_f32 v93, v251, v93
    v_lshlrev_b32 v94, 16, v247
    v_mfma_f32_16x16x32_bf16 v[44:47], v[184:187], v[68:71], v[44:47]
    v_and_b32 v95, 0xffff0000, v247
    v_mul_f32 v94, v251, v94
    v_mul_f32 v95, v251, v95
    v_mfma_f32_16x16x32_bf16 v[44:47], v[204:207], v[72:75], v[44:47]
    v_lshlrev_b32 v96, 16, v248
    v_and_b32 v97, 0xffff0000, v248
    v_mul_f32 v96, v251, v96
    v_mfma_f32_16x16x32_bf16 v[44:47], v[224:227], v[76:79], v[44:47]
    v_mul_f32 v97, v251, v97
    v_lshlrev_b32 v98, 16, v249
    v_mfma_f32_16x16x32_bf16 v[48:51], v[168:171], v[64:67], v[48:51]
    v_and_b32 v99, 0xffff0000, v249
    v_mul_f32 v98, v251, v98
    v_mul_f32 v99, v251, v99
    v_mfma_f32_16x16x32_bf16 v[48:51], v[188:191], v[68:71], v[48:51]
    v_fmac_f32 v80, v250, v40
    v_fmac_f32 v81, v250, v41
    v_mfma_f32_16x16x32_bf16 v[48:51], v[208:211], v[72:75], v[48:51]
    v_fmac_f32 v82, v250, v42
    v_fmac_f32 v83, v250, v43
    v_mfma_f32_16x16x32_bf16 v[48:51], v[228:231], v[76:79], v[48:51]
    v_cvt_pk_bf16_f32 v240, v80, v81
    v_cvt_pk_bf16_f32 v241, v82, v83
    v_mfma_f32_16x16x32_bf16 v[52:55], v[172:175], v[64:67], v[52:55]
    ds_write_b64 v12, v[240:241] offset:0
    v_fmac_f32 v84, v250, v44
    v_fmac_f32 v85, v250, v45
    v_mfma_f32_16x16x32_bf16 v[52:55], v[192:195], v[68:71], v[52:55]
    v_fmac_f32 v86, v250, v46
    v_fmac_f32 v87, v250, v47
    v_mfma_f32_16x16x32_bf16 v[52:55], v[212:215], v[72:75], v[52:55]
    v_cvt_pk_bf16_f32 v242, v84, v85
    v_cvt_pk_bf16_f32 v243, v86, v87
    v_mfma_f32_16x16x32_bf16 v[52:55], v[232:235], v[76:79], v[52:55]
    ds_write_b64 v12, v[242:243] offset:8
    buffer_load_dword v252, v253, s[52:55], s14 offen sc1
    v_mfma_f32_16x16x32_bf16 v[56:59], v[176:179], v[64:67], v[56:59]
    v_fmac_f32 v88, v250, v48
    v_fmac_f32 v89, v250, v49
    v_mfma_f32_16x16x32_bf16 v[56:59], v[196:199], v[68:71], v[56:59]
    v_fmac_f32 v90, v250, v50
    v_fmac_f32 v91, v250, v51
    v_mfma_f32_16x16x32_bf16 v[56:59], v[216:219], v[72:75], v[56:59]
    v_cvt_pk_bf16_f32 v244, v88, v89
    v_cvt_pk_bf16_f32 v245, v90, v91
    v_mfma_f32_16x16x32_bf16 v[56:59], v[236:239], v[76:79], v[56:59]
    ds_write_b64 v12, v[244:245] offset:16
    v_fmac_f32 v92, v250, v52
    v_fmac_f32 v93, v250, v53
    v_fmac_f32 v94, v250, v54
    v_fmac_f32 v95, v250, v55
    v_cvt_pk_bf16_f32 v246, v92, v93
    v_cvt_pk_bf16_f32 v247, v94, v95
    ds_write_b64 v12, v[246:247] offset:24
    v_fmac_f32 v96, v250, v56
    v_fmac_f32 v97, v250, v57
    v_fmac_f32 v98, v250, v58
    v_fmac_f32 v99, v250, v59
    v_cvt_pk_bf16_f32 v248, v96, v97
    v_cvt_pk_bf16_f32 v249, v98, v99
    ds_write_b64 v12, v[248:249] offset:32
    ds_read_b128 v[40:43], v13 offset:0
    ds_read_b128 v[44:47], v13 offset:1024
    ds_read_b128 v[48:51], v13 offset:2048
    s_cmp_eq_u32 s15, 0
    s_cbranch_scc1 L_ofree
    s_waitcnt vmcnt(0)
    v_cmp_eq_u32 vcc, s84, v252
    s_nop 0
    s_cmp_eq_u64 vcc, -1
    s_cbranch_scc0 L_retry_15
L_pdone_17:
L_ofree:
    s_waitcnt lgkmcnt(2)
    buffer_store_dwordx4 v[40:43], v1, s[44:47], s93 offen nt
    s_waitcnt lgkmcnt(1)
    buffer_store_dwordx4 v[44:47], v9, s[44:47], s93 offen nt
    s_waitcnt lgkmcnt(0)
    buffer_store_dwordx4 v[48:51], v255, s[44:47], s93 offen nt
    s_branch L_fin
L_await:
    s_sleep 2
    s_sub_u32 s91, s91, 1
    s_cbranch_scc0 L_apair
    s_branch L_agot
L_yget:
    v_mov_b32 v15, 161280
    s_waitcnt vmcnt(0)
    v_xor_b32 v101, v101, v100
    v_xor_b32 v103, v103, v102
    v_xor_b32 v105, v105, v104
    v_xor_b32 v107, v107, v106
    v_xor_b32 v109, v109, v108
    v_xor_b32 v111, v111, v110
    v_xor_b32 v113, v113, v112
    v_xor_b32 v115, v115, v114
    v_cmp_eq_u32 vcc, s84, v101
    v_cmp_eq_u32 s[58:59], s84, v103
    s_nop 0
    s_and_b64 vcc, vcc, s[58:59]
    v_cmp_eq_u32 s[58:59], s84, v105
    s_nop 0
    s_and_b64 vcc, vcc, s[58:59]
    v_cmp_eq_u32 s[58:59], s84, v107
    s_nop 0
    s_and_b64 vcc, vcc, s[58:59]
    v_cmp_eq_u32 s[58:59], s84, v109
    s_nop 0
    s_and_b64 vcc, vcc, s[58:59]
    v_cmp_eq_u32 s[58:59], s84, v111
    s_nop 0
    s_and_b64 vcc, vcc, s[58:59]
    v_cmp_eq_u32 s[58:59], s84, v113
    s_nop 0
    s_and_b64 vcc, vcc, s[58:59]
    v_cmp_eq_u32 s[58:59], s84, v115
    s_nop 0
    s_and_b64 vcc, vcc, s[58:59]
    s_cmp_eq_u64 vcc, -1
    s_cbranch_scc0 L_retry_18
L_pdone_20:
    v_add_f32 v100, v100, v104
    v_add_f32 v102, v102, v106
    v_add_f32 v100, v100, v108
    v_add_f32 v102, v102, v110
    v_add_f32 v100, v100, v112
    v_add_f32 v102, v102, v114
    v_mul_f32 v9, 0xbfb8aa3b, v251
    v_exp_f32 v9, v9
    v_lshrrev_b32 v1, 1, v1
    v_add_f32 v9, 1.0, v9
    v_rcp_f32 v9, v9
    v_add_u32 v1, v1, v15
    v_mul_f32 v100, v9, v100
    v_mul_f32 v101, v9, v102
    ds_write_b64 v1, v[100:101] offset:128
    v_mul_u32_u24 v1, 80, v8
    v_add_u32 v1, v1, v15
    ds_read_b128 v[100:103], v1 offset:128
    ds_read_b128 v[104:107], v1 offset:144
    ds_read_b128 v[108:111], v1 offset:160
    ds_read_b128 v[112:115], v1 offset:176
    ds_read_b128 v[116:119], v1 offset:192
    s_and_b32 s95, s56, 15
    v_cmp_eq_u32 vcc, s95, v7
    s_waitcnt lgkmcnt(0)
    s_mov_b64 exec, vcc
    v_lshlrev_b32 v12, 16, v240
    v_and_b32 v13, 0xffff0000, v240
    v_add_f32 v12, v12, v100
    v_add_f32 v13, v13, v101
    v_cvt_pk_bf16_f32 v240, v12, v13
    v_lshlrev_b32 v12, 16, v241
    v_and_b32 v13, 0xffff0000, v241
    v_add_f32 v12, v12, v102
    v_add_f32 v13, v13, v103
    v_cvt_pk_bf16_f32 v241, v12, v13
    v_lshlrev_b32 v12, 16, v242
    v_and_b32 v13, 0xffff0000, v242
    v_add_f32 v12, v12, v104
    v_add_f32 v13, v13, v105
    v_cvt_pk_bf16_f32 v242, v12, v13
    v_lshlrev_b32 v12, 16, v243
    v_and_b32 v13, 0xffff0000, v243
    v_add_f32 v12, v12, v106
    v_add_f32 v13, v13, v107
    v_cvt_pk_bf16_f32 v243, v12, v13
    v_lshlrev_b32 v12, 16, v244
    v_and_b32 v13, 0xffff0000, v244
    v_add_f32 v12, v12, v108
    v_add_f32 v13, v13, v109
    v_cvt_pk_bf16_f32 v244, v12, v13
    v_lshlrev_b32 v12, 16, v245
    v_and_b32 v13, 0xffff0000, v245
    v_add_f32 v12, v12, v110
    v_add_f32 v13, v13, v111
    v_cvt_pk_bf16_f32 v245, v12, v13
    v_lshlrev_b32 v12, 16, v246
    v_and_b32 v13, 0xffff0000, v246
    v_add_f32 v12, v12, v112
    v_add_f32 v13, v13, v113
    v_cvt_pk_bf16_f32 v246, v12, v13
    v_lshlrev_b32 v12, 16, v247
    v_and_b32 v13, 0xffff0000, v247
    v_add_f32 v12, v12, v114
    v_add_f32 v13, v13, v115
    v_cvt_pk_bf16_f32 v247, v12, v13
    v_lshlrev_b32 v12, 16, v248
    v_and_b32 v13, 0xffff0000, v248
    v_add_f32 v12, v12, v116
    v_add_f32 v13, v13, v117
    v_cvt_pk_bf16_f32 v248, v12, v13
    v_lshlrev_b32 v12, 16, v249
    v_and_b32 v13, 0xffff0000, v249
    v_add_f32 v12, v12, v118
    v_add_f32 v13, v13, v119
    v_cvt_pk_bf16_f32 v249, v12, v13
    s_mov_b64 exec, -1
    s_branch L_ygot
L_mwait:
    s_mov_b32 s91, 1048576
L_ls_21:
    ds_read_b32 v15, v226 offset:12
    s_waitcnt lgkmcnt(0)
    v_readfirstlane_b32 s97, v15
    s_nop 0
    s_cmp_ge_u32 s97, 8
    s_cbranch_scc1 L_lsd_22
    s_sub_u32 s91, s91, 1
    s_cbranch_scc0 L_ls_21
L_lsd_22:
    s_branch L_mfree
L_hook:
    s_cmp_ge_u32 s3, 4
    s_cbranch_scc1 L_hookb
    s_cmp_eq_u32 s88, 4
    s_cbranch_scc1 L_a4
    s_mov_b32 s57, 4
    s_waitcnt vmcnt(6)
    s_mov_b64 exec, 1
    ds_add_u32 v226, v227 offset:8
    s_mov_b64 exec, -1
    s_branch L_mid
L_a4:
    s_mov_b32 s57, 0
    s_cmp_lg_u32 s90, 0
    s_cbranch_scc1 L_a4x
    s_cmp_eq_u32 s3, 3
    s_cbranch_scc0 L_a4m
    v_mov_b32 v224, v225
    s_mov_b32 s24, 4
    s_mov_b32 s29, 64
    s_mov_b32 s27, 204800
    s_mul_i32 s25, s5, 160
L_a4m:
    s_cmp_lg_u32 s84, 0
    s_cbranch_scc0 L_nz_23
L_nzd_25:
    s_cmp_lt_u32 s6, 27
    s_cbranch_scc0 L_a4d
L_a4r:
    ds_read_b32 v15, v226 offset:8
    ds_read_b64 v[228:229], v9 offset:0
    ds_read_b64_tr_b16 v[230:231], v1 offset:0
    ds_read_b64 v[232:233], v9 offset:32
    ds_read_b64_tr_b16 v[234:235], v1 offset:2048
    ds_read_b64 v[236:237], v9 offset:64
    ds_read_b64_tr_b16 v[238:239], v1 offset:4096
    ds_read_b64 v[240:241], v9 offset:96
    ds_read_b64_tr_b16 v[242:243], v1 offset:6144
    ds_read_b64 v[244:245], v9 offset:128
    ds_read_b64_tr_b16 v[246:247], v1 offset:8192
    s_lshl2_add_u32 s92, s6, s3
    s_lshl4_add_u32 s92, s92, s100
    s_lshl_b32 s92, s92, 7
    s_add_u32 s92, s92, 3670016
    s_waitcnt lgkmcnt(8)
    v_readfirstlane_b32 s97, v15
    s_nop 0
    s_cmp_lt_u32 s97, 3
    s_cbranch_scc1 L_a4w
    v_mfma_f32_16x16x16_bf16 v[10:13], v[230:231], v[228:229], 0
    ds_read_b64 v[228:229], v254 offset:0
    ds_read_b64_tr_b16 v[230:231], v1 offset:10304
    s_waitcnt lgkmcnt(8)
    v_mfma_f32_16x16x16_bf16 v[10:13], v[234:235], v[232:233], v[10:13]
    ds_read_b64 v[232:233], v254 offset:32
    ds_read_b64_tr_b16 v[234:235], v1 offset:12352
    s_waitcnt lgkmcnt(8)
    v_mfma_f32_16x16x16_bf16 v[10:13], v[238:239], v[236:237], v[10:13]
    ds_read_b64 v[236:237], v254 offset:64
    ds_read_b64_tr_b16 v[238:239], v1 offset:14400
    s_waitcnt lgkmcnt(8)
    v_mfma_f32_16x16x16_bf16 v[10:13], v[242:243], v[240:241], v[10:13]
    ds_read_b64 v[240:241], v254 offset:96
    ds_read_b64_tr_b16 v[242:243], v1 offset:16448
    s_waitcnt lgkmcnt(8)
    v_mfma_f32_16x16x16_bf16 v[10:13], v[246:247], v[244:245], v[10:13]
    ds_read_b64 v[244:245], v254 offset:128
    ds_read_b64_tr_b16 v[246:247], v1 offset:18496
    s_waitcnt lgkmcnt(8)
    v_mfma_f32_16x16x16_bf16 v[10:13], v[230:231], v[228:229], v[10:13]
    s_waitcnt lgkmcnt(6)
    v_mfma_f32_16x16x16_bf16 v[10:13], v[234:235], v[232:233], v[10:13]
    s_waitcnt lgkmcnt(4)
    v_mfma_f32_16x16x16_bf16 v[10:13], v[238:239], v[236:237], v[10:13]
    s_waitcnt lgkmcnt(2)
    v_mfma_f32_16x16x16_bf16 v[10:13], v[242:243], v[240:241], v[10:13]
    s_waitcnt lgkmcnt(0)
    v_mfma_f32_16x16x16_bf16 v[10:13], v[246:247], v[244:245], v[10:13]
    s_mov_b32 exec_lo, 0xa000a
    s_mov_b32 exec_hi, 0xa000a
    s_nop 5
    v_xor_b32 v10, s84, v10
    v_xor_b32 v11, s84, v11
    v_xor_b32 v12, s84, v12
    v_xor_b32 v13, s84, v13
    s_mov_b32 exec_lo, 0xf000f
    s_mov_b32 exec_hi, 0xf000f
    buffer_store_dwordx4 v[10:13], v255, s[52:55], s92 offen sc1
    s_mov_b64 exec, -1
L_a4d:
    s_mov_b64 exec, 1
    ds_add_u32 v226, v227 offset:12
    s_mov_b64 exec, -1
L_a4x:
    ds_read_b96 v[228:230], v226 offset:16
    s_lshl2_add_u32 s94, s4, s3
    s_mul_i32 s92, s94, 20480
    s_mul_i32 s93, s5, 160
    s_add_u32 s93, s93, s92
    s_lshl_b32 s14, s94, 7
    s_add_u32 s14, s14, 3899392
    s_lshl_b32 s94, s94, 6
    s_add_u32 s94, s94, 819200
    v_lshl_add_u32 v15, v7, 5, v8
    v_mul_u32_u24 v15, 40, v15
    v_and_b32 v1, 60, v6
    buffer_load_dwordx4 v[240:243], v15, s[8:11], s93 offen
    buffer_load_dwordx4 v[244:247], v15, s[8:11], s93 offen offset:16
    buffer_load_dwordx2 v[248:249], v15, s[8:11], s93 offen offset:32
    buffer_load_dword v250, v1, s[52:55], s94 offen sc1
    buffer_load_dword v232, off, s[52:55], s14 sc1
    s_waitcnt lgkmcnt(0)
    v_readfirstlane_b32 s92, v230
    v_readfirstlane_b32 s56, v229
    v_mov_b32 v251, v228
    s_cmp_lg_u32 s92, 0
    s_cselect_b32 s15, 1, 0
    s_cselect_b64 s[32:33], s[44:45], s[32:33]
    s_setprio 1
L_back:
    s_cmp_lg_u32 s24, 0
    s_cselect_b64 vcc, -1, 0
    s_branch L_loop
L_a4w:
    s_mov_b32 s91, 1048576
L_ls_26:
    ds_read_b32 v15, v226 offset:8
    s_waitcnt lgkmcnt(0)
    v_readfirstlane_b32 s97, v15
    s_nop 0
    s_cmp_ge_u32 s97, 3
    s_cbranch_scc1 L_lsd_27
    s_sub_u32 s91, s91, 1
    s_cbranch_scc0 L_ls_26
L_lsd_27:
    s_branch L_a4r
L_hookb:
    s_cmp_eq_u32 s88, 5
    s_cbranch_scc1 L_b5
    s_cmp_eq_u32 s88, 2
    s_cbranch_scc1 L_b2
    s_mov_b32 s57, 0
    s_cmp_lg_u32 s90, 0
    s_cbranch_scc1 L_loop
    v_mov_b32 v224, v225
    s_mov_b32 s24, 4
    s_mov_b32 s29, 64
    s_mov_b32 s27, 204800
    s_mul_i32 s25, s5, 160
    s_cmp_lt_u32 s6, 27
    s_cselect_b32 s57, 0, 2
    s_cbranch_scc0 L_b4o
    s_lshl3_add_u32 s92, s6, s100
    s_mul_i32 s93, s3, 216
    s_add_u32 s92, s92, s93
    s_lshl_b32 s92, s92, 5
    s_add_u32 s92, s92, 955392
    v_mov_b32 v10, s84
    s_waitcnt vmcnt(8)
    s_mov_b64 exec, 1
    buffer_store_dword v10, off, s[52:55], s92 sc1
    s_mov_b64 exec, -1
L_b4o:
    buffer_load_dwordx4 v[228:231], v1, s[32:35], s12 offen sc1
    buffer_load_dwordx4 v[228:231], v1, s[32:35], s12 offen offset:512 sc1
    buffer_load_dwordx2 v[232:233], v1, s[32:35], s13 offen sc1
    buffer_load_dword v232, off, s[52:55], s14 sc1
    s_branch L_back
L_b5:
    s_mov_b32 s57, 4
    s_cmp_lg_u32 s90, 0
    s_cbranch_scc1 L_mid
    s_cmp_lt_u32 s6, 27
    s_cbranch_scc0 L_b5d
    s_setprio 3
    s_lshl3_add_u32 s92, s6, s100
    s_lshl_b32 s93, s92, 10
    s_add_u32 s93, s93, 3670016
    buffer_load_dword v10, v251, s[52:55], s93 offen offset:0 sc1
    buffer_load_dword v11, v251, s[52:55], s93 offen offset:512 sc1
    buffer_load_dword v12, v251, s[52:55], s93 offen offset:16 sc1
    buffer_load_dword v13, v251, s[52:55], s93 offen offset:528 sc1
    s_waitcnt vmcnt(0)
    v_xor_b32 v12, v12, v10
    v_xor_b32 v13, v13, v11
    v_cmp_eq_u32 vcc, s84, v12
    v_cmp_eq_u32 s[58:59], s84, v13
    s_nop 0
    s_and_b64 vcc, vcc, s[58:59]
    s_cmp_eq_u64 vcc, -1
    s_cbranch_scc0 L_retry_28
L_pdone_30:
    v_mfma_f32_16x16x4_f32 v[228:231], v248, v10, 0
    v_mfma_f32_16x16x4_f32 v[228:231], v248, v11, v[228:231]
    ds_read_b64_tr_b16 v[232:233], v254 offset:0
    ds_read_b64_tr_b16 v[234:235], v254 offset:5120
    ds_read_b64_tr_b16 v[236:237], v254 offset:128
    ds_read_b64_tr_b16 v[238:239], v254 offset:5248
    ds_read_b64_tr_b16 v[240:241], v254 offset:256
    ds_read_b64_tr_b16 v[242:243], v254 offset:5376
    s_mul_i32 s93, s92, 2560
    s_add_u32 s93, s93, 262144
    s_nop 3
    v_mul_f32 v11, 0xbfb8aa3b, v228
    v_exp_f32 v11, v11
    v_mul_f32_dpp v10, v228, v228 row_ror:8 row_mask:0xf bank_mask:0xf
    v_add_f32 v11, 1.0, v11
    v_rcp_f32 v11, v11
    s_mov_b64 exec, 0xff
    v_mul_f32 v10, v10, v11
    v_cvt_pk_bf16_f32 v10, v10, v10
    ds_write_b16 v249, v10 offset:64
    s_mov_b64 exec, -1
    ds_read_b128 v[10:13], v250 offset:64
    s_waitcnt lgkmcnt(0)
    v_mfma_f32_16x16x32_bf16 v[228:231], v[232:235], v[10:13], 0
    v_mfma_f32_16x16x32_bf16 v[232:235], v[236:239], v[10:13], 0
    v_mfma_f32_16x16x32_bf16 v[236:239], v[240:243], v[10:13], 0
    s_mov_b32 exec_lo, 0xf000f
    s_mov_b32 exec_hi, 0xf000f
    s_nop 3
    buffer_store_dwordx4 v[228:231], v253, s[52:55], s93 offen offset:0 sc1
    buffer_store_dwordx4 v[232:235], v253, s[52:55], s93 offen offset:256 sc1
    buffer_store_dwordx4 v[236:239], v253, s[52:55], s93 offen offset:512 sc1
    s_mov_b64 exec, -1
L_b5d:
    s_mov_b64 exec, 1
    ds_add_u32 v226, v227 offset:12
    s_mov_b64 exec, -1
    s_setprio 2
    s_cmp_lg_u32 s24, 0
    s_cselect_b64 vcc, -1, 0
    s_branch L_mid
L_b2:
    s_sub_u32 s92, s6, 27
    s_lshl3_add_u32 s92, s92, s100
    s_lshr_b32 s93, s92, 2
    s_max_u32 s93, s93, 1
    s_sub_u32 s93, s93, 1
    s_lshr_b32 s93, s93, 1
    s_min_u32 s93, s93, 3
    s_lshl2_add_u32 s93, s93, s3
    s_mul_i32 s93, s93, 1728
    s_add_u32 s93, s93, 976128
    v_min_u32 v15, 53, v0
    v_lshlrev_b32 v15, 5, v15
    buffer_load_dword v10, v15, s[52:55], s93 offen sc1
    s_waitcnt vmcnt(0)
    v_cmp_eq_u32 vcc, s84, v10
    s_nop 0
    s_cmp_eq_u64 vcc, -1
    s_cbranch_scc0 L_retry_31
L_pdone_33:
    v_lshrrev_b32 v15, 2, v0
    v_mul_u32_u24 v15, 2496, v15
    v_add_u32 v15, v15, v5
    s_lshl_b32 s92, s92, 6
    s_mul_i32 s93, s3, 138240
    s_add_u32 s93, s93, s92
    s_add_u32 s93, s93, -290816
    v_mov_b32 v10, 0
    v_mov_b32 v11, 0
    v_mov_b32 v12, 0
    v_mov_b32 v13, 0
    buffer_load_dwordx4 v[228:231], v15, s[52:55], s93 offen sc1
    s_add_u32 s93, s93, 40960
    buffer_load_dwordx4 v[232:235], v15, s[52:55], s93 offen sc1
    s_add_u32 s93, s93, 40960
    buffer_load_dwordx4 v[236:239], v15, s[52:55], s93 offen sc1
    s_add_u32 s93, s93, 40960
    s_mov_b64 exec, 0xffffff
    buffer_load_dwordx4 v[10:13], v15, s[52:55], s93 offen sc1
    s_mov_b64 exec, -1
    s_and_b32 s94, s92, 0xc0
    s_and_b32 s92, s92, -256
    s_lshr_b32 s94, s94, 1
    s_lshl1_add_u32 s92, s92, s94
    s_mul_i32 s93, s3, 5120
    s_add_u32 s93, s93, s92
    s_add_u32 s93, s93, 155648
    s_waitcnt vmcnt(0)
    v_add_f32 v10, v10, v228
    v_add_f32 v11, v11, v229
    v_add_f32 v12, v12, v230
    v_add_f32 v13, v13, v231
    v_add_f32 v10, v10, v232
    v_add_f32 v11, v11, v233
    v_add_f32 v12, v12, v234
    v_add_f32 v13, v13, v235
    v_add_f32 v10, v10, v236
    v_add_f32 v11, v11, v237
    v_add_f32 v12, v12, v238
    v_add_f32 v13, v13, v239
    v_add_f32_dpp v10, v10, v10 row_ror:4 row_mask:0xf bank_mask:0xf
    v_add_f32_dpp v11, v11, v11 row_ror:4 row_mask:0xf bank_mask:0xf
    v_add_f32_dpp v12, v12, v12 row_ror:4 row_mask:0xf bank_mask:0xf
    v_add_f32_dpp v13, v13, v13 row_ror:4 row_mask:0xf bank_mask:0xf
    v_add_f32_dpp v10, v10, v10 row_ror:8 row_mask:0xf bank_mask:0xf
    v_add_f32_dpp v11, v11, v11 row_ror:8 row_mask:0xf bank_mask:0xf
    v_add_f32_dpp v12, v12, v12 row_ror:8 row_mask:0xf bank_mask:0xf
    v_add_f32_dpp v13, v13, v13 row_ror:8 row_mask:0xf bank_mask:0xf
    v_mfma_f32_16x16x4_f32 v[228:231], v248, v10, 0
    v_mfma_f32_16x16x4_f32 v[232:235], v248, v11, 0
    v_mfma_f32_16x16x4_f32 v[236:239], v248, v12, 0
    v_mfma_f32_16x16x4_f32 v[240:243], v248, v13, 0
    v_lshlrev_b32 v10, 7, v0
    s_nop 7
    v_xor_b32 v229, s84, v228
    v_mov_b32 v230, v232
    v_xor_b32 v231, s84, v232
    v_xor_b32 v237, s84, v236
    v_mov_b32 v238, v240
    v_xor_b32 v239, s84, v240
    s_mov_b64 exec, 15
    buffer_store_dwordx4 v[228:231], v10, s[52:55], s93 offen sc1
    buffer_store_dwordx4 v[236:239], v10, s[52:55], s93 offen offset:16 sc1
    s_mov_b64 exec, -1
    s_branch L_last
L_nz_1:
    s_mov_b32 s91, 1048576
L_nzp_2:
    buffer_load_dword v10, off, s[48:51], 0 sc1
    s_waitcnt vmcnt(0)
    v_readfirstlane_b32 s84, v10
    s_nop 0
    s_cmp_lg_u32 s84, 0
    s_cbranch_scc1 L_nzd_3
    s_sub_u32 s91, s91, 1
    s_cbranch_scc0 L_nzp_2
    s_branch L_nzd_3
L_nz_4:
    s_mov_b32 s91, 1048576
L_nzp_5:
    buffer_load_dword v11, off, s[48:51], 0 sc1
    s_waitcnt vmcnt(0)
    v_readfirstlane_b32 s84, v11
    s_nop 0
    s_cmp_lg_u32 s84, 0
    s_cbranch_scc1 L_nzd_6
    s_sub_u32 s91, s91, 1
    s_cbranch_scc0 L_nzp_5
    s_branch L_nzd_6
L_retry_7:
    s_mov_b32 s91, 1048576
L_poll_8:
    s_sleep 8
    buffer_load_dword v11, v10, s[52:55], s92 offen sc1
    s_waitcnt vmcnt(0)
    v_and_b32 v11, -16, v11
    v_cmp_eq_u32 vcc, s84, v11
    s_nop 0
    s_cmp_eq_u64 vcc, -1
    s_cbranch_scc1 L_pdone_9
    s_sub_u32 s91, s91, 1
    s_cbranch_scc0 L_poll_8
    s_branch L_pdone_9
L_retry_15:
    s_mov_b32 s91, 1048576
L_poll_16:
    buffer_load_dword v252, v253, s[52:55], s14 offen sc1
    s_waitcnt vmcnt(0)
    v_cmp_eq_u32 vcc, s84, v252
    s_nop 0
    s_cmp_eq_u64 vcc, -1
    s_cbranch_scc1 L_pdone_17
    s_sub_u32 s91, s91, 1
    s_cbranch_scc0 L_poll_16
    s_branch L_pdone_17
L_retry_18:
    s_mov_b32 s91, 1048576
L_poll_19:
    s_sleep 4
    s_add_u32 s58, s96, 0
    buffer_load_dwordx4 v[100:103], v1, s[52:55], s58 offen sc1
    s_add_u32 s58, s96, 5120
    buffer_load_dwordx4 v[104:107], v1, s[52:55], s58 offen sc1
    s_add_u32 s58, s96, 10240
    buffer_load_dwordx4 v[108:111], v1, s[52:55], s58 offen sc1
    s_add_u32 s58, s96, 15360
    buffer_load_dwordx4 v[112:115], v1, s[52:55], s58 offen sc1
    s_waitcnt vmcnt(0)
    v_xor_b32 v101, v101, v100
    v_xor_b32 v103, v103, v102
    v_xor_b32 v105, v105, v104
    v_xor_b32 v107, v107, v106
    v_xor_b32 v109, v109, v108
    v_xor_b32 v111, v111, v110
    v_xor_b32 v113, v113, v112
    v_xor_b32 v115, v115, v114
    v_cmp_eq_u32 vcc, s84, v101
    v_cmp_eq_u32 s[58:59], s84, v103
    s_nop 0
    s_and_b64 vcc, vcc, s[58:59]
    v_cmp_eq_u32 s[58:59], s84, v105
    s_nop 0
    s_and_b64 vcc, vcc, s[58:59]
    v_cmp_eq_u32 s[58:59], s84, v107
    s_nop 0
    s_and_b64 vcc, vcc, s[58:59]
    v_cmp_eq_u32 s[58:59], s84, v109
    s_nop 0
    s_and_b64 vcc, vcc, s[58:59]
    v_cmp_eq_u32 s[58:59], s84, v111
    s_nop 0
    s_and_b64 vcc, vcc, s[58:59]
    v_cmp_eq_u32 s[58:59], s84, v113
    s_nop 0
    s_and_b64 vcc, vcc, s[58:59]
    v_cmp_eq_u32 s[58:59], s84, v115
    s_nop 0
    s_and_b64 vcc, vcc, s[58:59]
    s_cmp_eq_u64 vcc, -1
    s_cbranch_scc1 L_pdone_20
    s_sub_u32 s91, s91, 1
    s_cbranch_scc0 L_poll_19
    s_branch L_pdone_20
L_nz_23:
    s_mov_b32 s91, 1048576
L_nzp_24:
    buffer_load_dword v15, off, s[48:51], 0 sc1
    s_waitcnt vmcnt(0)
    v_readfirstlane_b32 s84, v15
    s_nop 0
    s_cmp_lg_u32 s84, 0
    s_cbranch_scc1 L_nzd_25
    s_sub_u32 s91, s91, 1
    s_cbranch_scc0 L_nzp_24
    s_branch L_nzd_25
L_retry_28:
    s_mov_b32 s91, 1048576
L_poll_29:
    s_sleep 8
    buffer_load_dword v10, v251, s[52:55], s93 offen offset:0 sc1
    buffer_load_dword v11, v251, s[52:55], s93 offen offset:512 sc1
    buffer_load_dword v12, v251, s[52:55], s93 offen offset:16 sc1
    buffer_load_dword v13, v251, s[52:55], s93 offen offset:528 sc1
    s_waitcnt vmcnt(0)
    v_xor_b32 v12, v12, v10
    v_xor_b32 v13, v13, v11
    v_cmp_eq_u32 vcc, s84, v12
    v_cmp_eq_u32 s[58:59], s84, v13
    s_nop 0
    s_and_b64 vcc, vcc, s[58:59]
    s_cmp_eq_u64 vcc, -1
    s_cbranch_scc1 L_pdone_30
    s_sub_u32 s91, s91, 1
    s_cbranch_scc0 L_poll_29
    s_branch L_pdone_30
L_retry_31:
    s_mov_b32 s91, 1048576
L_poll_32:
    s_sleep 16
    buffer_load_dword v10, v15, s[52:55], s93 offen sc1
    s_waitcnt vmcnt(0)
    v_cmp_eq_u32 vcc, s84, v10
    s_nop 0
    s_cmp_eq_u64 vcc, -1
    s_cbranch_scc1 L_pdone_33
    s_sub_u32 s91, s91, 1
    s_cbranch_scc0 L_poll_32
    s_branch L_pdone_33
L_bad:
    ds_write_b32 v226, v227 offset:4
    s_waitcnt lgkmcnt(0)
    s_barrier
L_redo:
    s_mov_b32 s90, 1
    s_mov_b32 s24, 0
    s_setprio 0
    s_waitcnt vmcnt(0) lgkmcnt(0)
    v_mov_b32 v226, 161280
    v_mov_b32 v227, 1
    v_mov_b64 v[152:153], 0
    v_mov_b64 v[154:155], 0
    v_mov_b64 v[156:157], 0
    v_mov_b64 v[158:159], 0
    v_cmp_gt_u32 vcc, 32, v0
    v_mov_b32 v11, 0x3f803f80
    v_and_b32 v12, 27, v0
    v_mfma_f32_32x32x8_bf16 v[160:175], v[152:153], v[152:153], 0
    v_cndmask_b32 v57, 0, v11, vcc
    v_mfma_f32_32x32x8_bf16 v[176:191], v[152:153], v[152:153], 0
    v_cndmask_b32 v59, 0, v11, vcc
    v_mfma_f32_32x32x8_bf16 v[192:207], v[152:153], v[152:153], 0
    v_cndmask_b32 v61, 0, v11, vcc
    v_mfma_f32_32x32x8_bf16 v[208:223], v[152:153], v[152:153], 0
    v_cndmask_b32 v63, 0, v11, vcc
    v_cmp_eq_u32 vcc, 18, v12
    v_mov_b32 v14, 0xdddddddd
    s_nop 0
    v_cndmask_b32 v64, 0, v11, vcc
    v_cndmask_b32 v65, 0, v11, vcc
    v_mov_b64 v[66:67], v[64:65]
    v_mov_b64 v[68:69], v[64:65]
    v_mov_b64 v[70:71], v[64:65]
    v_mov_b64 v[72:73], v[64:65]
    v_mov_b64 v[74:75], v[64:65]
    v_mov_b64 v[76:77], v[64:65]
    v_mov_b64 v[78:79], v[64:65]
    v_mov_b64 v[80:81], v[64:65]
    v_mov_b64 v[82:83], v[64:65]
    v_mov_b64 v[84:85], v[64:65]
    v_mov_b64 v[86:87], v[64:65]
    v_mov_b64 v[88:89], v[64:65]
    v_mov_b64 v[90:91], v[64:65]
    v_mov_b64 v[92:93], v[64:65]
    v_mov_b64 v[94:95], v[64:65]
    s_lshl_b32 s96, s101, 7
    s_xor_b32 s97, s96, 256
    s_add_u32 s96, s96, 161792
    s_add_u32 s97, s97, 161792
    v_add_u32 v240, s96, v6
    v_and_b32 v242, 124, v6
    v_add_u32 v241, s96, v242
    v_add_u32 v242, s97, v242
    s_lshl_b32 s92, s3, 7
    s_add_u32 s92, s92, 161792
    v_and_b32 v15, 124, v6
    v_add_u32 v15, s92, v15
    v_mov_b32 v10, 0xff800000
    ds_write_b32 v15, v10
    s_mov_b32 s88, 16
    s_mul_i32 s87, s86, 40960
    v_mov_b32 v21, 0
    v_mov_b32 v228, v10
    v_mov_b32 v27, 0
    v_mov_b32 v229, v10
    v_mov_b32 v33, 0
    v_mov_b32 v230, v10
    v_mov_b32 v39, 0
    v_mov_b32 v231, v10
    s_waitcnt lgkmcnt(0)
    s_barrier
L_tm:
    buffer_load_dwordx4 v[40:43], v2, s[36:39], s87 offen
    buffer_load_dword v56, v3, s[36:39], s87 offen offset:512
    s_add_u32 s87, s87, 2560
    s_waitcnt vmcnt(0)
    v_mfma_f32_32x32x16_bf16 v[96:111], v[40:43], v[16:19], 0
    v_mfma_f32_32x32x8_bf16 v[96:111], v[56:57], v[20:21], v[96:111]
    s_nop 11
    v_max3_f32 v228, v96, v97, v228
    v_max3_f32 v228, v98, v99, v228
    v_max3_f32 v228, v100, v101, v228
    v_max3_f32 v228, v102, v103, v228
    v_max3_f32 v228, v104, v105, v228
    v_max3_f32 v228, v106, v107, v228
    v_max3_f32 v228, v108, v109, v228
    v_max3_f32 v228, v110, v111, v228
    v_mfma_f32_32x32x16_bf16 v[96:111], v[40:43], v[22:25], 0
    v_mfma_f32_32x32x8_bf16 v[96:111], v[56:57], v[26:27], v[96:111]
    s_nop 11
    v_max3_f32 v229, v96, v97, v229
    v_max3_f32 v229, v98, v99, v229
    v_max3_f32 v229, v100, v101, v229
    v_max3_f32 v229, v102, v103, v229
    v_max3_f32 v229, v104, v105, v229
    v_max3_f32 v229, v106, v107, v229
    v_max3_f32 v229, v108, v109, v229
    v_max3_f32 v229, v110, v111, v229
    v_mfma_f32_32x32x16_bf16 v[96:111], v[40:43], v[28:31], 0
    v_mfma_f32_32x32x8_bf16 v[96:111], v[56:57], v[32:33], v[96:111]
    s_nop 11
    v_max3_f32 v230, v96, v97, v230
    v_max3_f32 v230, v98, v99, v230
    v_max3_f32 v230, v100, v101, v230
    v_max3_f32 v230, v102, v103, v230
    v_max3_f32 v230, v104, v105, v230
    v_max3_f32 v230, v106, v107, v230
    v_max3_f32 v230, v108, v109, v230
    v_max3_f32 v230, v110, v111, v230
    v_mfma_f32_32x32x16_bf16 v[96:111], v[40:43], v[34:37], 0
    v_mfma_f32_32x32x8_bf16 v[96:111], v[56:57], v[38:39], v[96:111]
    s_nop 11
    v_max3_f32 v231, v96, v97, v231
    v_max3_f32 v231, v98, v99, v231
    v_max3_f32 v231, v100, v101, v231
    v_max3_f32 v231, v102, v103, v231
    v_max3_f32 v231, v104, v105, v231
    v_max3_f32 v231, v106, v107, v231
    v_max3_f32 v231, v108, v109, v231
    v_max3_f32 v231, v110, v111, v231
    s_sub_u32 s88, s88, 1
    s_cmp_lg_u32 s88, 0
    s_cbranch_scc1 L_tm
    ds_max_f32 v241, v228 offset:0
    ds_max_f32 v241, v229 offset:128
    ds_max_f32 v242, v230 offset:0
    ds_max_f32 v242, v231 offset:128
    s_mul_i32 s87, s86, 40960
    buffer_load_dwordx4 v[40:43], v2, s[36:39], s87 offen
    buffer_load_dword v56, v3, s[36:39], s87 offen offset:512
    s_mul_i32 s97, s86, 16
    s_bitset1_b32 s97, 0
    s_mul_i32 s97, s97, 2560
    buffer_load_dwordx4 v[44:47], v2, s[36:39], s97 offen
    buffer_load_dword v58, v3, s[36:39], s97 offen offset:512
    s_mov_b64 exec, s[98:99]
    buffer_load_dwordx4 v[64:67], v4, s[36:39], s87 offen offset:1280
    buffer_load_dwordx4 v[80:83], v4, s[36:39], s87 offen offset:1920
    s_mov_b64 exec, -1
    s_add_u32 s87, s87, 2560
    s_mov_b64 exec, s[98:99]
    buffer_load_dwordx4 v[68:71], v4, s[36:39], s87 offen offset:1280
    buffer_load_dwordx4 v[84:87], v4, s[36:39], s87 offen offset:1920
    s_mov_b64 exec, -1
    s_add_u32 s87, s87, 2560
    buffer_load_dwordx4 v[48:51], v2, s[36:39], s87 offen
    buffer_load_dword v60, v3, s[36:39], s87 offen offset:512
    s_mov_b64 exec, s[98:99]
    buffer_load_dwordx4 v[72:75], v4, s[36:39], s87 offen offset:1280
    buffer_load_dwordx4 v[88:91], v4, s[36:39], s87 offen offset:1920
    s_mov_b64 exec, -1
    s_cmp_ge_u32 s3, 4
    s_cbranch_scc1 L_rdx
    s_and_b32 s96, s3, 3
    s_xor_b32 s97, s3, 1
    s_mul_i32 s96, s96, 6144
    s_mul_i32 s97, s97, 6144
    s_add_u32 s96, s96, 102400
    s_add_u32 s97, s97, 102400
    v_add_u32 v252, s97, v5
    v_add_u32 v253, s96, v5
L_rdx:
    s_waitcnt vmcnt(0) lgkmcnt(0)
    s_barrier
    ds_read_b32 v10, v15
    s_waitcnt lgkmcnt(0)
    v_cvt_pk_bf16_f32 v11, 0, v10
    v_sub_f32 v11, v11, v10
    v_cvt_pk_bf16_f32 v10, -v10, v11
    ds_write_b32 v15, v10
    s_branch L_biasrd
L_fin:
L_end:
    s_endpgm
.section .rodata,"a"
.p2align 6
.amdhsa_kernel gated_mix__grouped_kv_mqa__moe_arch_mod__prompt_kernel
  .amdhsa_next_free_vgpr 256
  .amdhsa_next_free_sgpr 102
  .amdhsa_accum_offset 256
  .amdhsa_group_segment_fixed_size 0
  .amdhsa_kernarg_size 112
  .amdhsa_user_sgpr_count 2
  .amdhsa_user_sgpr_kernarg_segment_ptr 1
  .amdhsa_system_sgpr_workgroup_id_x 1
.end_amdhsa_kernel
```
